```python
import torch

def _softmax(x, axis=-1):
    return torch.softmax(x, dim=axis)
def _gelu(x):
    return torch.nn.functional.gelu(x, approximate="tanh")
def _silu(x):
    return torch.nn.functional.silu(x)
def _sigmoid(x):
    return torch.sigmoid(x)
def _layernorm(x, axis=-1, eps=1e-5):
    m = x.mean(dim=axis, keepdim=True)
    v = x.var(dim=axis, keepdim=True, unbiased=False)
    return (x - m) / torch.sqrt(v + eps)
def _scatter_add(tgt, idx, src, axis=0):
    return tgt.clone().index_add_(axis, idx, src)
def _segment_sum(src, seg, n):
    out = torch.zeros((n,) + src.shape[1:], dtype=src.dtype)
    return out.index_add_(0, seg, src)
def _pad(x, pw):
    flat = tuple(v for pair in reversed(pw) for v in pair)
    return torch.nn.functional.pad(x, flat)

kernel_name = 'standalone__weight_only_int_omniquant__prompt'

def setup_inputs():

    _w = (lambda a: (lambda t: t.to(torch.bfloat16) if t.is_floating_point() else t)(torch.as_tensor(a)))
    B, S, D, F = 1, 2048, 1024, 3584
    bits = 3
    G = 128 if 128 > 0 else D
    D = (D // G) * G
    ng = D // G
    qmax = (1 << bits) - 1
    qw = torch.randint(0, qmax + 1, (D, F)).to(torch.int32)
    scales = (torch.abs((lambda *s: torch.randn(*s, dtype=torch.bfloat16) * 0.05)(ng, F)) * 0.05 + 0.01).to(float)
    zeros = torch.randint(0, qmax + 1, (ng, F)).to(float)
    act_scale = (torch.abs((lambda *s: torch.randn(*s, dtype=torch.bfloat16) * 0.05)(D)) * 0.5 + 0.5).to(float)
    return {
        "x": _w((lambda *s: torch.randn(*s, dtype=torch.bfloat16) * 0.05)(B, S, D)),
        "qw": _w(qw),
        "scales": _w(scales),
        "zeros": _w(zeros),
        "act_scale": _w(act_scale),
    }

def reference(x, qw, scales, zeros, act_scale):
    B, S, D = x.shape
    ng, F = scales.shape
    G = D // ng
    s = (lambda x, n, axis: torch.repeat_interleave(x, n, dim=axis))(scales, G, axis=0)
    z = (lambda x, n, axis: torch.repeat_interleave(x, n, dim=axis))(zeros, G, axis=0)
    w = ((lambda x, dt: x.to(dt))(qw, x.dtype) - z) * s
    xs = x * (lambda x, dt: x.to(dt))(act_scale, x.dtype)
    return torch.einsum("bsd,df->bsf", xs, w)
```

```asm
; @launch grid=(256,1,1) block=(512,1,1) lds=157248
.amdgcn_target "amdgcn-amd-amdhsa--gfx950"
.text
.p2align 8
.globl standalone__weight_only_int_omniquant__prompt_kernel
.type standalone__weight_only_int_omniquant__prompt_kernel,@function
standalone__weight_only_int_omniquant__prompt_kernel:
    s_cmp_ge_u32 s2, 256
    s_cbranch_scc1 L_end
    s_load_dwordx16 s[4:19], s[0:1], 0
    v_lshrrev_b32 v1, 6, v0
    v_and_b32 v2, 63, v0
    v_readfirstlane_b32 s22, v1
    s_bfe_u32 s23, s2, 0x20001
    s_lshl_b32 s23, s23, 3
    s_lshr_b32 s56, s2, 6
    s_lshl_b32 s56, s56, 1
    s_add_u32 s23, s23, s56
    s_bfe_u32 s56, s2, 0x10005
    s_add_u32 s21, s23, s56
    s_and_b32 s23, s2, 1
    s_lshl_b32 s23, s23, 2
    s_bfe_u32 s56, s2, 0x20003
    s_add_u32 s20, s23, s56
    s_lshl_b32 s23, s20, 1
    s_cmp_ge_u32 s22, 4
    s_cbranch_scc1 L_loader
    v_cmp_le_u32 vcc, 28, v2
    s_lshl_b32 s56, s22, 1
    v_mov_b32 v192, 0x7f000000
    v_cndmask_b32 v191, 0, 1, vcc
    v_add_u32 v189, s56, v191
    v_mul_u32_u24 v191, 28, v191
    v_sub_u32 v190, v2, v191
    v_cmp_le_u32 vcc, 56, v2
    v_mul_u32_u24 v210, 0x1c000, v189
    v_lshl_add_u32 v210, v190, 4, v210
    v_cndmask_b32 v210, v210, v192, vcc
    v_lshlrev_b32 v211, 3, v190
    v_lshlrev_b32 v212, 4, v189
    s_waitcnt lgkmcnt(0)
    s_mov_b32 s36, s6
    s_and_b32 s37, s7, 0xffff
    s_mov_b32 s38, 14680064
    s_mov_b32 s39, 0x00020000
    s_mul_i32 s56, s23, 917504
    s_mul_i32 s57, s21, 448
    s_add_u32 s56, s56, s57
    buffer_load_dwordx4 v[112:115], v210, s[36:39], s56 offen nt
    s_add_u32 s56, s56, 14336
    buffer_load_dwordx4 v[116:119], v210, s[36:39], s56 offen nt
    s_add_u32 s56, s56, 14336
    buffer_load_dwordx4 v[120:123], v210, s[36:39], s56 offen nt
    s_add_u32 s56, s56, 14336
    buffer_load_dwordx4 v[124:127], v210, s[36:39], s56 offen nt
    s_add_u32 s56, s56, 14336
    buffer_load_dwordx4 v[128:131], v210, s[36:39], s56 offen nt
    s_add_u32 s56, s56, 14336
    buffer_load_dwordx4 v[132:135], v210, s[36:39], s56 offen nt
    s_add_u32 s56, s56, 14336
    buffer_load_dwordx4 v[136:139], v210, s[36:39], s56 offen nt
    s_add_u32 s56, s56, 14336
    buffer_load_dwordx4 v[140:143], v210, s[36:39], s56 offen nt
    s_mov_b32 s40, s8
    s_and_b32 s41, s9, 0xffff
    s_mov_b32 s42, 57344
    s_mov_b32 s43, 0x00020000
    s_mov_b32 s44, s10
    s_and_b32 s45, s11, 0xffff
    s_mov_b32 s46, 57344
    s_mov_b32 s47, 0x00020000
    s_mov_b32 s48, s12
    s_and_b32 s49, s13, 0xffff
    s_mov_b32 s50, 2048
    s_mov_b32 s51, 0x00020000
    s_mul_i32 s57, s20, 7168
    s_mul_i32 s58, s21, 224
    s_add_u32 s57, s57, s58
    s_lshl_b32 s58, s23, 7
    buffer_load_dwordx2 v[176:177], v211, s[40:43], s57 offen
    buffer_load_dwordx2 v[178:179], v211, s[44:47], s57 offen
    buffer_load_dwordx4 v[180:183], v212, s[48:51], s58 offen
    s_mov_b32 s24, s4
    s_and_b32 s25, s5, 0xffff
    s_mov_b32 s26, 4194304
    s_mov_b32 s27, 0x00020000
    s_mov_b32 s32, s14
    s_and_b32 s33, s15, 0xffff
    s_mov_b32 s34, 14680064
    s_mov_b32 s35, 0x00020000
    v_lshrrev_b32 v191, 3, v190
    v_and_b32 v192, 1, v190
    v_lshl_add_u32 v191, v191, 1, v192
    v_bfe_u32 v192, v190, 1, 2
    v_cmp_le_u32 vcc, 24, v190
    v_lshl_add_u32 v191, v191, 2, v192
    v_mul_u32_u24 v213, 1792, v189
    v_cndmask_b32 v191, v191, v190, vcc
    v_lshl_add_u32 v213, v191, 4, v213
    v_add_u32 v213, 32768, v213
    v_and_b32 v10, 15, v2
    v_lshrrev_b32 v11, 4, v2
    v_lshrrev_b32 v12, 1, v10
    v_xor_b32 v12, v12, v11
    v_lshlrev_b32 v12, 4, v12
    v_lshl_add_u32 v203, v10, 7, v12
    s_lshl_b32 s56, s22, 13
    v_add_u32 v203, s56, v203
    v_xor_b32 v204, 64, v203
    v_mul_u32_u24 v205, 1792, v11
    v_and_b32 v12, 3, v10
    v_mul_u32_u24 v12, 448, v12
    v_lshrrev_b32 v13, 2, v10
    v_lshl_add_u32 v12, v13, 4, v12
    v_add_u32 v205, v205, v12
    v_add_u32 v205, 32768, v205
    v_mov_b32 v200, v203
    v_mov_b32 v201, v204
    v_mov_b32 v202, v205
    v_and_b32 v209, 31, v2
    s_lshl_b32 s56, s22, 5
    v_add_u32 v209, s56, v209
    v_lshlrev_b32 v209, 7, v209
    s_add_u32 s71, s23, 1
    s_waitcnt vmcnt(0)
    v_lshlrev_b32 v160, 16, v176
    v_and_b32 v161, 0xffff0000, v176
    v_lshlrev_b32 v164, 16, v178
    v_and_b32 v165, 0xffff0000, v178
    v_lshlrev_b32 v162, 16, v177
    v_and_b32 v163, 0xffff0000, v177
    v_lshlrev_b32 v166, 16, v179
    v_and_b32 v167, 0xffff0000, v179
    v_mul_f32 v164, v164, v160
    v_mul_f32 v165, v165, v161
    v_mul_f32 v166, v166, v162
    v_mul_f32 v167, v167, v163
    v_lshlrev_b32 v168, 16, v180
    v_and_b32 v169, 0xffff0000, v180
    v_lshlrev_b32 v170, 16, v181
    v_and_b32 v171, 0xffff0000, v181
    v_lshlrev_b32 v172, 16, v182
    v_and_b32 v173, 0xffff0000, v182
    v_lshlrev_b32 v174, 16, v183
    v_and_b32 v175, 0xffff0000, v183
    v_cvt_f32_i32 v112, v112
    v_cvt_f32_i32 v113, v113
    v_cvt_f32_i32 v114, v114
    v_cvt_f32_i32 v115, v115
    v_cvt_f32_i32 v116, v116
    v_cvt_f32_i32 v117, v117
    v_cvt_f32_i32 v118, v118
    v_cvt_f32_i32 v119, v119
    v_pk_fma_f32 v[112:113], v[112:113], v[160:161], v[164:165] neg_lo:[0,0,1] neg_hi:[0,0,1]
    v_pk_fma_f32 v[114:115], v[114:115], v[162:163], v[166:167] neg_lo:[0,0,1] neg_hi:[0,0,1]
    v_pk_fma_f32 v[116:117], v[116:117], v[160:161], v[164:165] neg_lo:[0,0,1] neg_hi:[0,0,1]
    v_pk_fma_f32 v[118:119], v[118:119], v[162:163], v[166:167] neg_lo:[0,0,1] neg_hi:[0,0,1]
    v_pk_mul_f32 v[112:113], v[112:113], v[168:169] op_sel:[0,0] op_sel_hi:[1,0]
    v_pk_mul_f32 v[114:115], v[114:115], v[168:169] op_sel:[0,0] op_sel_hi:[1,0]
    v_pk_mul_f32 v[116:117], v[116:117], v[168:169] op_sel:[0,1] op_sel_hi:[1,1]
    v_pk_mul_f32 v[118:119], v[118:119], v[168:169] op_sel:[0,1] op_sel_hi:[1,1]
    v_cvt_pk_bf16_f32 v144, v112, v116
    v_cvt_pk_bf16_f32 v148, v113, v117
    v_cvt_pk_bf16_f32 v152, v114, v118
    v_cvt_pk_bf16_f32 v156, v115, v119
    v_cvt_f32_i32 v120, v120
    v_cvt_f32_i32 v121, v121
    v_cvt_f32_i32 v122, v122
    v_cvt_f32_i32 v123, v123
    v_cvt_f32_i32 v124, v124
    v_cvt_f32_i32 v125, v125
    v_cvt_f32_i32 v126, v126
    v_cvt_f32_i32 v127, v127
    v_pk_fma_f32 v[120:121], v[120:121], v[160:161], v[164:165] neg_lo:[0,0,1] neg_hi:[0,0,1]
    v_pk_fma_f32 v[122:123], v[122:123], v[162:163], v[166:167] neg_lo:[0,0,1] neg_hi:[0,0,1]
    v_pk_fma_f32 v[124:125], v[124:125], v[160:161], v[164:165] neg_lo:[0,0,1] neg_hi:[0,0,1]
    v_pk_fma_f32 v[126:127], v[126:127], v[162:163], v[166:167] neg_lo:[0,0,1] neg_hi:[0,0,1]
    v_pk_mul_f32 v[120:121], v[120:121], v[170:171] op_sel:[0,0] op_sel_hi:[1,0]
    v_pk_mul_f32 v[122:123], v[122:123], v[170:171] op_sel:[0,0] op_sel_hi:[1,0]
    v_pk_mul_f32 v[124:125], v[124:125], v[170:171] op_sel:[0,1] op_sel_hi:[1,1]
    v_pk_mul_f32 v[126:127], v[126:127], v[170:171] op_sel:[0,1] op_sel_hi:[1,1]
    v_cvt_pk_bf16_f32 v145, v120, v124
    v_cvt_pk_bf16_f32 v149, v121, v125
    v_cvt_pk_bf16_f32 v153, v122, v126
    v_cvt_pk_bf16_f32 v157, v123, v127
    v_cvt_f32_i32 v128, v128
    v_cvt_f32_i32 v129, v129
    v_cvt_f32_i32 v130, v130
    v_cvt_f32_i32 v131, v131
    v_cvt_f32_i32 v132, v132
    v_cvt_f32_i32 v133, v133
    v_cvt_f32_i32 v134, v134
    v_cvt_f32_i32 v135, v135
    v_pk_fma_f32 v[128:129], v[128:129], v[160:161], v[164:165] neg_lo:[0,0,1] neg_hi:[0,0,1]
    v_pk_fma_f32 v[130:131], v[130:131], v[162:163], v[166:167] neg_lo:[0,0,1] neg_hi:[0,0,1]
    v_pk_fma_f32 v[132:133], v[132:133], v[160:161], v[164:165] neg_lo:[0,0,1] neg_hi:[0,0,1]
    v_pk_fma_f32 v[134:135], v[134:135], v[162:163], v[166:167] neg_lo:[0,0,1] neg_hi:[0,0,1]
    v_pk_mul_f32 v[128:129], v[128:129], v[172:173] op_sel:[0,0] op_sel_hi:[1,0]
    v_pk_mul_f32 v[130:131], v[130:131], v[172:173] op_sel:[0,0] op_sel_hi:[1,0]
    v_pk_mul_f32 v[132:133], v[132:133], v[172:173] op_sel:[0,1] op_sel_hi:[1,1]
    v_pk_mul_f32 v[134:135], v[134:135], v[172:173] op_sel:[0,1] op_sel_hi:[1,1]
    v_cvt_pk_bf16_f32 v146, v128, v132
    v_cvt_pk_bf16_f32 v150, v129, v133
    v_cvt_pk_bf16_f32 v154, v130, v134
    v_cvt_pk_bf16_f32 v158, v131, v135
    v_cvt_f32_i32 v136, v136
    v_cvt_f32_i32 v137, v137
    v_cvt_f32_i32 v138, v138
    v_cvt_f32_i32 v139, v139
    v_cvt_f32_i32 v140, v140
    v_cvt_f32_i32 v141, v141
    v_cvt_f32_i32 v142, v142
    v_cvt_f32_i32 v143, v143
    v_pk_fma_f32 v[136:137], v[136:137], v[160:161], v[164:165] neg_lo:[0,0,1] neg_hi:[0,0,1]
    v_pk_fma_f32 v[138:139], v[138:139], v[162:163], v[166:167] neg_lo:[0,0,1] neg_hi:[0,0,1]
    v_pk_fma_f32 v[140:141], v[140:141], v[160:161], v[164:165] neg_lo:[0,0,1] neg_hi:[0,0,1]
    v_pk_fma_f32 v[142:143], v[142:143], v[162:163], v[166:167] neg_lo:[0,0,1] neg_hi:[0,0,1]
    v_pk_mul_f32 v[136:137], v[136:137], v[174:175] op_sel:[0,0] op_sel_hi:[1,0]
    v_pk_mul_f32 v[138:139], v[138:139], v[174:175] op_sel:[0,0] op_sel_hi:[1,0]
    v_pk_mul_f32 v[140:141], v[140:141], v[174:175] op_sel:[0,1] op_sel_hi:[1,1]
    v_pk_mul_f32 v[142:143], v[142:143], v[174:175] op_sel:[0,1] op_sel_hi:[1,1]
    v_cvt_pk_bf16_f32 v147, v136, v140
    v_cvt_pk_bf16_f32 v151, v137, v141
    v_cvt_pk_bf16_f32 v155, v138, v142
    v_cvt_pk_bf16_f32 v159, v139, v143
    s_mov_b32 exec_hi, 0x00ffffff
    ds_write_b128 v213, v[144:147] offset:0
    ds_write_b128 v213, v[148:151] offset:448
    ds_write_b128 v213, v[152:155] offset:896
    ds_write_b128 v213, v[156:159] offset:1344
    s_mov_b32 exec_hi, -1
    s_waitcnt lgkmcnt(0)
    s_barrier
    ds_read_b128 v[112:115], v200 offset:0
    ds_read_b128 v[128:131], v202 offset:0
    ds_read_b128 v[116:119], v200 offset:2048
    ds_read_b128 v[120:123], v200 offset:4096
    ds_read_b128 v[124:127], v200 offset:6144
    ds_read_b128 v[132:135], v202 offset:64
    ds_read_b128 v[136:139], v202 offset:128
    ds_read_b128 v[140:143], v202 offset:192
    ds_read_b128 v[144:147], v202 offset:256
    ds_read_b128 v[148:151], v202 offset:320
    ds_read_b128 v[152:155], v202 offset:384
    s_mov_b32 s67, 0
    s_mov_b32 s66, 0
    s_waitcnt lgkmcnt(0)
    v_mfma_f32_16x16x32_bf16 v[0:3], v[128:131], v[112:115], 0
    ds_read_b128 v[156:159], v201 offset:0
    v_mfma_f32_16x16x32_bf16 v[4:7], v[128:131], v[116:119], 0
    v_mfma_f32_16x16x32_bf16 v[8:11], v[128:131], v[120:123], 0
    ds_read_b128 v[172:175], v202 offset:7168
    v_mfma_f32_16x16x32_bf16 v[12:15], v[128:131], v[124:127], 0
    v_mfma_f32_16x16x32_bf16 v[28:31], v[132:135], v[124:127], 0
    ds_read_b128 v[160:163], v201 offset:2048
    v_mfma_f32_16x16x32_bf16 v[24:27], v[132:135], v[120:123], 0
    v_mfma_f32_16x16x32_bf16 v[20:23], v[132:135], v[116:119], 0
    ds_read_b128 v[164:167], v201 offset:4096
    v_mfma_f32_16x16x32_bf16 v[16:19], v[132:135], v[112:115], 0
    v_mfma_f32_16x16x32_bf16 v[32:35], v[136:139], v[112:115], 0
    ds_read_b128 v[168:171], v201 offset:6144
    v_mfma_f32_16x16x32_bf16 v[36:39], v[136:139], v[116:119], 0
    v_mfma_f32_16x16x32_bf16 v[40:43], v[136:139], v[120:123], 0
    ds_read_b128 v[176:179], v202 offset:7232
    v_mfma_f32_16x16x32_bf16 v[44:47], v[136:139], v[124:127], 0
    v_mfma_f32_16x16x32_bf16 v[60:63], v[140:143], v[124:127], 0
    ds_read_b128 v[180:183], v202 offset:7296
    v_mfma_f32_16x16x32_bf16 v[56:59], v[140:143], v[120:123], 0
    v_mfma_f32_16x16x32_bf16 v[52:55], v[140:143], v[116:119], 0
    ds_read_b128 v[184:187], v202 offset:7360
    v_mfma_f32_16x16x32_bf16 v[48:51], v[140:143], v[112:115], 0
    v_mfma_f32_16x16x32_bf16 v[64:67], v[144:147], v[112:115], 0
    ds_read_b128 v[188:191], v202 offset:7424
    v_mfma_f32_16x16x32_bf16 v[68:71], v[144:147], v[116:119], 0
    v_mfma_f32_16x16x32_bf16 v[72:75], v[144:147], v[120:123], 0
    ds_read_b128 v[192:195], v202 offset:7488
    v_mfma_f32_16x16x32_bf16 v[76:79], v[144:147], v[124:127], 0
    v_mfma_f32_16x16x32_bf16 v[92:95], v[148:151], v[124:127], 0
    ds_read_b128 v[196:199], v202 offset:7552
    v_mfma_f32_16x16x32_bf16 v[88:91], v[148:151], v[120:123], 0
    v_mfma_f32_16x16x32_bf16 v[84:87], v[148:151], v[116:119], 0
    v_mfma_f32_16x16x32_bf16 v[80:83], v[148:151], v[112:115], 0
    s_add_u32 s68, s66, 47104
    s_cmp_eq_u32 s68, 141312
    s_cselect_b32 s66, 0, s68
    v_mfma_f32_16x16x32_bf16 v[96:99], v[152:155], v[112:115], 0
    v_mfma_f32_16x16x32_bf16 v[100:103], v[152:155], v[116:119], 0
    v_add_u32 v200, s66, v203
    v_mfma_f32_16x16x32_bf16 v[104:107], v[152:155], v[120:123], 0
    v_add_u32 v201, s66, v204
    v_add_u32 v202, s66, v205
    v_mfma_f32_16x16x32_bf16 v[108:111], v[152:155], v[124:127], 0
    s_barrier
    s_mul_i32 s56, s71, 917504
    s_mul_i32 s57, s21, 448
    s_add_u32 s56, s56, s57
    buffer_load_dwordx4 v[216:219], v210, s[36:39], s56 offen nt
    s_add_u32 s56, s56, 14336
    buffer_load_dwordx4 v[220:223], v210, s[36:39], s56 offen nt
    s_add_u32 s56, s56, 14336
    buffer_load_dwordx4 v[224:227], v210, s[36:39], s56 offen nt
    s_add_u32 s56, s56, 14336
    buffer_load_dwordx4 v[228:231], v210, s[36:39], s56 offen nt
    s_add_u32 s56, s56, 14336
    buffer_load_dwordx4 v[232:235], v210, s[36:39], s56 offen nt
    s_add_u32 s56, s56, 14336
    buffer_load_dwordx4 v[236:239], v210, s[36:39], s56 offen nt
    s_add_u32 s56, s56, 14336
    buffer_load_dwordx4 v[240:243], v210, s[36:39], s56 offen nt
    s_add_u32 s56, s56, 14336
    buffer_load_dwordx4 v[244:247], v210, s[36:39], s56 offen nt
    s_mul_i32 s57, s20, 7168
    s_mul_i32 s58, s21, 224
    s_add_u32 s57, s57, s58
    s_lshl_b32 s58, s71, 7
    buffer_load_dwordx2 v[248:249], v211, s[40:43], s57 offen
    buffer_load_dwordx2 v[250:251], v211, s[44:47], s57 offen
    buffer_load_dwordx4 v[252:255], v212, s[48:51], s58 offen
    s_waitcnt vmcnt(0)
    v_lshlrev_b32 v112, 16, v248
    v_and_b32 v113, 0xffff0000, v248
    v_lshlrev_b32 v116, 16, v250
    v_and_b32 v117, 0xffff0000, v250
    v_lshlrev_b32 v114, 16, v249
    v_and_b32 v115, 0xffff0000, v249
    v_lshlrev_b32 v118, 16, v251
    v_and_b32 v119, 0xffff0000, v251
    v_mul_f32 v116, v116, v112
    v_mul_f32 v117, v117, v113
    v_mul_f32 v118, v118, v114
    v_mul_f32 v119, v119, v115
    v_lshlrev_b32 v120, 16, v252
    v_and_b32 v121, 0xffff0000, v252
    v_lshlrev_b32 v122, 16, v253
    v_and_b32 v123, 0xffff0000, v253
    v_lshlrev_b32 v124, 16, v254
    v_and_b32 v125, 0xffff0000, v254
    v_lshlrev_b32 v126, 16, v255
    v_and_b32 v127, 0xffff0000, v255
    v_cvt_f32_i32 v216, v216
    v_cvt_f32_i32 v217, v217
    v_cvt_f32_i32 v218, v218
    v_cvt_f32_i32 v219, v219
    v_cvt_f32_i32 v220, v220
    v_cvt_f32_i32 v221, v221
    v_cvt_f32_i32 v222, v222
    v_cvt_f32_i32 v223, v223
    v_pk_fma_f32 v[216:217], v[216:217], v[112:113], v[116:117] neg_lo:[0,0,1] neg_hi:[0,0,1]
    v_pk_fma_f32 v[218:219], v[218:219], v[114:115], v[118:119] neg_lo:[0,0,1] neg_hi:[0,0,1]
    v_pk_fma_f32 v[220:221], v[220:221], v[112:113], v[116:117] neg_lo:[0,0,1] neg_hi:[0,0,1]
    v_pk_fma_f32 v[222:223], v[222:223], v[114:115], v[118:119] neg_lo:[0,0,1] neg_hi:[0,0,1]
    v_pk_mul_f32 v[216:217], v[216:217], v[120:121] op_sel:[0,0] op_sel_hi:[1,0]
    v_pk_mul_f32 v[218:219], v[218:219], v[120:121] op_sel:[0,0] op_sel_hi:[1,0]
    v_pk_mul_f32 v[220:221], v[220:221], v[120:121] op_sel:[0,1] op_sel_hi:[1,1]
    v_pk_mul_f32 v[222:223], v[222:223], v[120:121] op_sel:[0,1] op_sel_hi:[1,1]
    v_cvt_pk_bf16_f32 v128, v216, v220
    v_cvt_pk_bf16_f32 v132, v217, v221
    v_cvt_pk_bf16_f32 v136, v218, v222
    v_cvt_pk_bf16_f32 v140, v219, v223
    v_cvt_f32_i32 v224, v224
    v_cvt_f32_i32 v225, v225
    v_cvt_f32_i32 v226, v226
    v_cvt_f32_i32 v227, v227
    v_cvt_f32_i32 v228, v228
    v_cvt_f32_i32 v229, v229
    v_cvt_f32_i32 v230, v230
    v_cvt_f32_i32 v231, v231
    v_pk_fma_f32 v[224:225], v[224:225], v[112:113], v[116:117] neg_lo:[0,0,1] neg_hi:[0,0,1]
    v_pk_fma_f32 v[226:227], v[226:227], v[114:115], v[118:119] neg_lo:[0,0,1] neg_hi:[0,0,1]
    v_pk_fma_f32 v[228:229], v[228:229], v[112:113], v[116:117] neg_lo:[0,0,1] neg_hi:[0,0,1]
    v_pk_fma_f32 v[230:231], v[230:231], v[114:115], v[118:119] neg_lo:[0,0,1] neg_hi:[0,0,1]
    v_pk_mul_f32 v[224:225], v[224:225], v[122:123] op_sel:[0,0] op_sel_hi:[1,0]
    v_pk_mul_f32 v[226:227], v[226:227], v[122:123] op_sel:[0,0] op_sel_hi:[1,0]
    v_pk_mul_f32 v[228:229], v[228:229], v[122:123] op_sel:[0,1] op_sel_hi:[1,1]
    v_pk_mul_f32 v[230:231], v[230:231], v[122:123] op_sel:[0,1] op_sel_hi:[1,1]
    v_cvt_pk_bf16_f32 v129, v224, v228
    v_cvt_pk_bf16_f32 v133, v225, v229
    v_cvt_pk_bf16_f32 v137, v226, v230
    v_cvt_pk_bf16_f32 v141, v227, v231
    v_cvt_f32_i32 v232, v232
    v_cvt_f32_i32 v233, v233
    v_cvt_f32_i32 v234, v234
    v_cvt_f32_i32 v235, v235
    v_cvt_f32_i32 v236, v236
    v_cvt_f32_i32 v237, v237
    v_cvt_f32_i32 v238, v238
    v_cvt_f32_i32 v239, v239
    v_pk_fma_f32 v[232:233], v[232:233], v[112:113], v[116:117] neg_lo:[0,0,1] neg_hi:[0,0,1]
    v_pk_fma_f32 v[234:235], v[234:235], v[114:115], v[118:119] neg_lo:[0,0,1] neg_hi:[0,0,1]
    v_pk_fma_f32 v[236:237], v[236:237], v[112:113], v[116:117] neg_lo:[0,0,1] neg_hi:[0,0,1]
    v_pk_fma_f32 v[238:239], v[238:239], v[114:115], v[118:119] neg_lo:[0,0,1] neg_hi:[0,0,1]
    v_pk_mul_f32 v[232:233], v[232:233], v[124:125] op_sel:[0,0] op_sel_hi:[1,0]
    v_pk_mul_f32 v[234:235], v[234:235], v[124:125] op_sel:[0,0] op_sel_hi:[1,0]
    v_pk_mul_f32 v[236:237], v[236:237], v[124:125] op_sel:[0,1] op_sel_hi:[1,1]
    v_pk_mul_f32 v[238:239], v[238:239], v[124:125] op_sel:[0,1] op_sel_hi:[1,1]
    v_cvt_pk_bf16_f32 v130, v232, v236
    v_cvt_pk_bf16_f32 v134, v233, v237
    v_cvt_pk_bf16_f32 v138, v234, v238
    v_cvt_pk_bf16_f32 v142, v235, v239
    v_cvt_f32_i32 v240, v240
    v_cvt_f32_i32 v241, v241
    v_cvt_f32_i32 v242, v242
    v_cvt_f32_i32 v243, v243
    v_cvt_f32_i32 v244, v244
    v_cvt_f32_i32 v245, v245
    v_cvt_f32_i32 v246, v246
    v_cvt_f32_i32 v247, v247
    v_pk_fma_f32 v[240:241], v[240:241], v[112:113], v[116:117] neg_lo:[0,0,1] neg_hi:[0,0,1]
    v_pk_fma_f32 v[242:243], v[242:243], v[114:115], v[118:119] neg_lo:[0,0,1] neg_hi:[0,0,1]
    v_pk_fma_f32 v[244:245], v[244:245], v[112:113], v[116:117] neg_lo:[0,0,1] neg_hi:[0,0,1]
    v_pk_fma_f32 v[246:247], v[246:247], v[114:115], v[118:119] neg_lo:[0,0,1] neg_hi:[0,0,1]
    v_pk_mul_f32 v[240:241], v[240:241], v[126:127] op_sel:[0,0] op_sel_hi:[1,0]
    v_pk_mul_f32 v[242:243], v[242:243], v[126:127] op_sel:[0,0] op_sel_hi:[1,0]
    v_pk_mul_f32 v[244:245], v[244:245], v[126:127] op_sel:[0,1] op_sel_hi:[1,1]
    v_pk_mul_f32 v[246:247], v[246:247], v[126:127] op_sel:[0,1] op_sel_hi:[1,1]
    v_cvt_pk_bf16_f32 v131, v240, v244
    v_cvt_pk_bf16_f32 v135, v241, v245
    v_cvt_pk_bf16_f32 v139, v242, v246
    v_cvt_pk_bf16_f32 v143, v243, v247
    s_mov_b32 exec_hi, 0x00ffffff
    ds_write_b128 v213, v[128:131] offset:47104
    ds_write_b128 v213, v[132:135] offset:47552
    ds_write_b128 v213, v[136:139] offset:48000
    ds_write_b128 v213, v[140:143] offset:48448
    s_mov_b32 exec_hi, -1
    s_waitcnt lgkmcnt(0)
    s_branch L_mid
L_loop:
    v_mfma_f32_16x16x32_bf16 v[0:3], v[128:131], v[112:115], v[0:3]
    ds_read_b128 v[156:159], v201 offset:0
    v_mfma_f32_16x16x32_bf16 v[4:7], v[128:131], v[116:119], v[4:7]
    v_mfma_f32_16x16x32_bf16 v[8:11], v[128:131], v[120:123], v[8:11]
    ds_read_b128 v[172:175], v202 offset:7168
    v_mfma_f32_16x16x32_bf16 v[12:15], v[128:131], v[124:127], v[12:15]
    v_mfma_f32_16x16x32_bf16 v[28:31], v[132:135], v[124:127], v[28:31]
    ds_read_b128 v[160:163], v201 offset:2048
    v_mfma_f32_16x16x32_bf16 v[24:27], v[132:135], v[120:123], v[24:27]
    v_mfma_f32_16x16x32_bf16 v[20:23], v[132:135], v[116:119], v[20:23]
    ds_read_b128 v[164:167], v201 offset:4096
    v_mfma_f32_16x16x32_bf16 v[16:19], v[132:135], v[112:115], v[16:19]
    v_mfma_f32_16x16x32_bf16 v[32:35], v[136:139], v[112:115], v[32:35]
    ds_read_b128 v[168:171], v201 offset:6144
    v_mfma_f32_16x16x32_bf16 v[36:39], v[136:139], v[116:119], v[36:39]
    v_mfma_f32_16x16x32_bf16 v[40:43], v[136:139], v[120:123], v[40:43]
    ds_read_b128 v[176:179], v202 offset:7232
    v_mfma_f32_16x16x32_bf16 v[44:47], v[136:139], v[124:127], v[44:47]
    v_mfma_f32_16x16x32_bf16 v[60:63], v[140:143], v[124:127], v[60:63]
    ds_read_b128 v[180:183], v202 offset:7296
    v_mfma_f32_16x16x32_bf16 v[56:59], v[140:143], v[120:123], v[56:59]
    v_mfma_f32_16x16x32_bf16 v[52:55], v[140:143], v[116:119], v[52:55]
    ds_read_b128 v[184:187], v202 offset:7360
    v_mfma_f32_16x16x32_bf16 v[48:51], v[140:143], v[112:115], v[48:51]
    v_mfma_f32_16x16x32_bf16 v[64:67], v[144:147], v[112:115], v[64:67]
    ds_read_b128 v[188:191], v202 offset:7424
    v_mfma_f32_16x16x32_bf16 v[68:71], v[144:147], v[116:119], v[68:71]
    v_mfma_f32_16x16x32_bf16 v[72:75], v[144:147], v[120:123], v[72:75]
    ds_read_b128 v[192:195], v202 offset:7488
    v_mfma_f32_16x16x32_bf16 v[76:79], v[144:147], v[124:127], v[76:79]
    v_mfma_f32_16x16x32_bf16 v[92:95], v[148:151], v[124:127], v[92:95]
    ds_read_b128 v[196:199], v202 offset:7552
    v_mfma_f32_16x16x32_bf16 v[88:91], v[148:151], v[120:123], v[88:91]
    v_mfma_f32_16x16x32_bf16 v[84:87], v[148:151], v[116:119], v[84:87]
    v_mfma_f32_16x16x32_bf16 v[80:83], v[148:151], v[112:115], v[80:83]
    s_add_u32 s68, s66, 47104
    s_cmp_eq_u32 s68, 141312
    s_cselect_b32 s66, 0, s68
    v_mfma_f32_16x16x32_bf16 v[96:99], v[152:155], v[112:115], v[96:99]
    v_mfma_f32_16x16x32_bf16 v[100:103], v[152:155], v[116:119], v[100:103]
    v_add_u32 v200, s66, v203
    v_mfma_f32_16x16x32_bf16 v[104:107], v[152:155], v[120:123], v[104:107]
    v_add_u32 v201, s66, v204
    v_add_u32 v202, s66, v205
    v_mfma_f32_16x16x32_bf16 v[108:111], v[152:155], v[124:127], v[108:111]
    s_waitcnt lgkmcnt(0)
L_mid:
    s_barrier
    v_mfma_f32_16x16x32_bf16 v[0:3], v[172:175], v[156:159], v[0:3]
    ds_read_b128 v[112:115], v200 offset:0
    v_mfma_f32_16x16x32_bf16 v[4:7], v[172:175], v[160:163], v[4:7]
    v_mfma_f32_16x16x32_bf16 v[8:11], v[172:175], v[164:167], v[8:11]
    ds_read_b128 v[128:131], v202 offset:0
    v_mfma_f32_16x16x32_bf16 v[12:15], v[172:175], v[168:171], v[12:15]
    v_mfma_f32_16x16x32_bf16 v[28:31], v[176:179], v[168:171], v[28:31]
    ds_read_b128 v[116:119], v200 offset:2048
    v_mfma_f32_16x16x32_bf16 v[24:27], v[176:179], v[164:167], v[24:27]
    v_mfma_f32_16x16x32_bf16 v[20:23], v[176:179], v[160:163], v[20:23]
    ds_read_b128 v[120:123], v200 offset:4096
    v_mfma_f32_16x16x32_bf16 v[16:19], v[176:179], v[156:159], v[16:19]
    v_mfma_f32_16x16x32_bf16 v[32:35], v[180:183], v[156:159], v[32:35]
    ds_read_b128 v[124:127], v200 offset:6144
    v_mfma_f32_16x16x32_bf16 v[36:39], v[180:183], v[160:163], v[36:39]
    v_mfma_f32_16x16x32_bf16 v[40:43], v[180:183], v[164:167], v[40:43]
    ds_read_b128 v[132:135], v202 offset:64
    v_mfma_f32_16x16x32_bf16 v[44:47], v[180:183], v[168:171], v[44:47]
    v_mfma_f32_16x16x32_bf16 v[60:63], v[184:187], v[168:171], v[60:63]
    ds_read_b128 v[136:139], v202 offset:128
    v_mfma_f32_16x16x32_bf16 v[56:59], v[184:187], v[164:167], v[56:59]
    v_mfma_f32_16x16x32_bf16 v[52:55], v[184:187], v[160:163], v[52:55]
    ds_read_b128 v[140:143], v202 offset:192
    v_mfma_f32_16x16x32_bf16 v[48:51], v[184:187], v[156:159], v[48:51]
    v_mfma_f32_16x16x32_bf16 v[64:67], v[188:191], v[156:159], v[64:67]
    ds_read_b128 v[144:147], v202 offset:256
    v_mfma_f32_16x16x32_bf16 v[68:71], v[188:191], v[160:163], v[68:71]
    v_mfma_f32_16x16x32_bf16 v[72:75], v[188:191], v[164:167], v[72:75]
    ds_read_b128 v[148:151], v202 offset:320
    v_mfma_f32_16x16x32_bf16 v[76:79], v[188:191], v[168:171], v[76:79]
    v_mfma_f32_16x16x32_bf16 v[92:95], v[192:195], v[168:171], v[92:95]
    ds_read_b128 v[152:155], v202 offset:384
    v_mfma_f32_16x16x32_bf16 v[88:91], v[192:195], v[164:167], v[88:91]
    v_mfma_f32_16x16x32_bf16 v[84:87], v[192:195], v[160:163], v[84:87]
    v_mfma_f32_16x16x32_bf16 v[80:83], v[192:195], v[156:159], v[80:83]
    v_mfma_f32_16x16x32_bf16 v[96:99], v[196:199], v[156:159], v[96:99]
    v_mfma_f32_16x16x32_bf16 v[100:103], v[196:199], v[160:163], v[100:103]
    v_mfma_f32_16x16x32_bf16 v[104:107], v[196:199], v[164:167], v[104:107]
    v_mfma_f32_16x16x32_bf16 v[108:111], v[196:199], v[168:171], v[108:111]
    s_add_u32 s67, s67, 1
    s_cmp_eq_u32 s67, 13
    s_waitcnt lgkmcnt(0)
    s_cbranch_scc0 L_loop
    v_mfma_f32_16x16x32_bf16 v[0:3], v[128:131], v[112:115], v[0:3]
    ds_read_b128 v[156:159], v204 offset:47104
    v_mbcnt_lo_u32_b32 v220, -1, 0
    v_mbcnt_hi_u32_b32 v220, -1, v220
    s_mul_i32 s56, s22, 3840
    v_mfma_f32_16x16x32_bf16 v[4:7], v[128:131], v[116:119], v[4:7]
    ds_read_b128 v[172:175], v205 offset:54272
    s_add_u32 s56, s56, 141376
    v_and_b32 v221, 15, v220
    v_lshrrev_b32 v222, 4, v220
    v_mfma_f32_16x16x32_bf16 v[20:23], v[132:135], v[116:119], v[20:23]
    ds_read_b128 v[160:163], v204 offset:49152
    v_mul_u32_u24 v221, 240, v221
    v_add_u32 v221, s56, v221
    v_lshl_add_u32 v216, v222, 4, v221
    v_mfma_f32_16x16x32_bf16 v[16:19], v[132:135], v[112:115], v[16:19]
    ds_read_b128 v[176:179], v205 offset:54336
    v_lshl_add_u32 v217, v222, 3, v221
    v_mul_u32_u24 v221, 4682, v220
    v_lshrrev_b32 v221, 16, v221
    v_mfma_f32_16x16x32_bf16 v[32:35], v[136:139], v[112:115], v[32:35]
    ds_read_b128 v[180:183], v205 offset:54400
    v_mul_u32_u24 v222, 14, v221
    v_sub_u32 v222, v220, v222
    v_mul_u32_u24 v218, 240, v221
    v_mfma_f32_16x16x32_bf16 v[36:39], v[136:139], v[116:119], v[36:39]
    ds_read_b128 v[184:187], v205 offset:54464
    v_lshl_add_u32 v218, v222, 4, v218
    v_add_u32 v218, s56, v218
    s_lshl_b32 s57, s20, 8
    v_mfma_f32_16x16x32_bf16 v[52:55], v[140:143], v[116:119], v[52:55]
    ds_read_b128 v[188:191], v205 offset:54528
    s_lshl_b32 s58, s22, 6
    s_add_u32 s57, s57, s58
    v_add_u32 v221, s57, v221
    v_mfma_f32_16x16x32_bf16 v[48:51], v[140:143], v[112:115], v[48:51]
    ds_read_b128 v[192:195], v205 offset:54592
    v_mul_u32_u24 v221, 7168, v221
    s_mul_i32 s57, s21, 224
    v_lshl_add_u32 v219, v222, 4, v221
    v_mfma_f32_16x16x32_bf16 v[64:67], v[144:147], v[112:115], v[64:67]
    ds_read_b128 v[196:199], v205 offset:54656
    v_add_u32 v219, s57, v219
    v_cmp_le_u32 vcc, 56, v220
    v_mov_b32 v221, 0x7f000000
    v_mfma_f32_16x16x32_bf16 v[68:71], v[144:147], v[116:119], v[68:71]
    s_mov_b32 s60, 0
    v_cndmask_b32 v219, v219, v221, vcc
    v_add_u32 v220, 94208, v203
    v_mfma_f32_16x16x32_bf16 v[84:87], v[148:151], v[116:119], v[84:87]
    v_add_u32 v221, 94208, v204
    v_add_u32 v222, 94208, v205
    v_mfma_f32_16x16x32_bf16 v[80:83], v[148:151], v[112:115], v[80:83]
    v_mfma_f32_16x16x32_bf16 v[96:99], v[152:155], v[112:115], v[96:99]
    v_mfma_f32_16x16x32_bf16 v[100:103], v[152:155], v[116:119], v[100:103]
    s_waitcnt lgkmcnt(0)
    s_barrier
    v_mfma_f32_16x16x32_bf16 v[0:3], v[172:175], v[156:159], v[0:3]
    ds_read_b128 v[112:115], v220 offset:0
    v_mfma_f32_16x16x32_bf16 v[4:7], v[172:175], v[160:163], v[4:7]
    ds_read_b128 v[128:131], v222 offset:0
    v_mfma_f32_16x16x32_bf16 v[20:23], v[176:179], v[160:163], v[20:23]
    ds_read_b128 v[116:119], v220 offset:2048
    v_mfma_f32_16x16x32_bf16 v[16:19], v[176:179], v[156:159], v[16:19]
    ds_read_b128 v[132:135], v222 offset:64
    v_mfma_f32_16x16x32_bf16 v[32:35], v[180:183], v[156:159], v[32:35]
    ds_read_b128 v[136:139], v222 offset:128
    v_mfma_f32_16x16x32_bf16 v[36:39], v[180:183], v[160:163], v[36:39]
    ds_read_b128 v[140:143], v222 offset:192
    v_mfma_f32_16x16x32_bf16 v[52:55], v[184:187], v[160:163], v[52:55]
    ds_read_b128 v[144:147], v222 offset:256
    v_mfma_f32_16x16x32_bf16 v[48:51], v[184:187], v[156:159], v[48:51]
    ds_read_b128 v[148:151], v222 offset:320
    v_mfma_f32_16x16x32_bf16 v[64:67], v[188:191], v[156:159], v[64:67]
    ds_read_b128 v[152:155], v222 offset:384
    v_mfma_f32_16x16x32_bf16 v[68:71], v[188:191], v[160:163], v[68:71]
    v_mfma_f32_16x16x32_bf16 v[84:87], v[192:195], v[160:163], v[84:87]
    v_mfma_f32_16x16x32_bf16 v[80:83], v[192:195], v[156:159], v[80:83]
    v_mfma_f32_16x16x32_bf16 v[96:99], v[196:199], v[156:159], v[96:99]
    v_mfma_f32_16x16x32_bf16 v[100:103], v[196:199], v[160:163], v[100:103]
    s_waitcnt lgkmcnt(0)
    v_mfma_f32_16x16x32_bf16 v[0:3], v[128:131], v[112:115], v[0:3]
    ds_read_b128 v[156:159], v221 offset:0
    v_mfma_f32_16x16x32_bf16 v[4:7], v[128:131], v[116:119], v[4:7]
    ds_read_b128 v[172:175], v222 offset:7168
    v_mfma_f32_16x16x32_bf16 v[20:23], v[132:135], v[116:119], v[20:23]
    ds_read_b128 v[160:163], v221 offset:2048
    v_mfma_f32_16x16x32_bf16 v[16:19], v[132:135], v[112:115], v[16:19]
    ds_read_b128 v[176:179], v222 offset:7232
    v_mfma_f32_16x16x32_bf16 v[32:35], v[136:139], v[112:115], v[32:35]
    ds_read_b128 v[180:183], v222 offset:7296
    v_mfma_f32_16x16x32_bf16 v[36:39], v[136:139], v[116:119], v[36:39]
    ds_read_b128 v[184:187], v222 offset:7360
    v_mfma_f32_16x16x32_bf16 v[52:55], v[140:143], v[116:119], v[52:55]
    ds_read_b128 v[188:191], v222 offset:7424
    v_mfma_f32_16x16x32_bf16 v[48:51], v[140:143], v[112:115], v[48:51]
    ds_read_b128 v[192:195], v222 offset:7488
    v_mfma_f32_16x16x32_bf16 v[64:67], v[144:147], v[112:115], v[64:67]
    ds_read_b128 v[196:199], v222 offset:7552
    v_mfma_f32_16x16x32_bf16 v[68:71], v[144:147], v[116:119], v[68:71]
    v_mfma_f32_16x16x32_bf16 v[84:87], v[148:151], v[116:119], v[84:87]
    v_mfma_f32_16x16x32_bf16 v[80:83], v[148:151], v[112:115], v[80:83]
    v_mfma_f32_16x16x32_bf16 v[96:99], v[152:155], v[112:115], v[96:99]
    v_mfma_f32_16x16x32_bf16 v[100:103], v[152:155], v[116:119], v[100:103]
    s_waitcnt lgkmcnt(0)
    s_barrier
    v_mfma_f32_16x16x32_bf16 v[0:3], v[172:175], v[156:159], v[0:3]
    ds_read_b128 v[112:115], v203 offset:0
    v_mfma_f32_16x16x32_bf16 v[4:7], v[172:175], v[160:163], v[4:7]
    ds_read_b128 v[128:131], v205 offset:0
    v_mfma_f32_16x16x32_bf16 v[20:23], v[176:179], v[160:163], v[20:23]
    ds_read_b128 v[116:119], v203 offset:2048
    v_mfma_f32_16x16x32_bf16 v[16:19], v[176:179], v[156:159], v[16:19]
    ds_read_b128 v[132:135], v205 offset:64
    v_mfma_f32_16x16x32_bf16 v[32:35], v[180:183], v[156:159], v[32:35]
    ds_read_b128 v[136:139], v205 offset:128
    v_mfma_f32_16x16x32_bf16 v[36:39], v[180:183], v[160:163], v[36:39]
    ds_read_b128 v[140:143], v205 offset:192
    v_mfma_f32_16x16x32_bf16 v[52:55], v[184:187], v[160:163], v[52:55]
    ds_read_b128 v[144:147], v205 offset:256
    v_mfma_f32_16x16x32_bf16 v[48:51], v[184:187], v[156:159], v[48:51]
    ds_read_b128 v[148:151], v205 offset:320
    v_mfma_f32_16x16x32_bf16 v[64:67], v[188:191], v[156:159], v[64:67]
    ds_read_b128 v[152:155], v205 offset:384
    v_mfma_f32_16x16x32_bf16 v[68:71], v[188:191], v[160:163], v[68:71]
    v_mfma_f32_16x16x32_bf16 v[84:87], v[192:195], v[160:163], v[84:87]
    v_mfma_f32_16x16x32_bf16 v[80:83], v[192:195], v[156:159], v[80:83]
    v_mfma_f32_16x16x32_bf16 v[96:99], v[196:199], v[156:159], v[96:99]
    v_mfma_f32_16x16x32_bf16 v[100:103], v[196:199], v[160:163], v[100:103]
    s_waitcnt lgkmcnt(0)
    v_mfma_f32_16x16x32_bf16 v[0:3], v[128:131], v[112:115], v[0:3]
    ds_read_b128 v[156:159], v204 offset:0
    v_mfma_f32_16x16x32_bf16 v[4:7], v[128:131], v[116:119], v[4:7]
    ds_read_b128 v[172:175], v205 offset:7168
    v_mfma_f32_16x16x32_bf16 v[20:23], v[132:135], v[116:119], v[20:23]
    ds_read_b128 v[160:163], v204 offset:2048
    v_mfma_f32_16x16x32_bf16 v[16:19], v[132:135], v[112:115], v[16:19]
    ds_read_b128 v[176:179], v205 offset:7232
    v_mfma_f32_16x16x32_bf16 v[32:35], v[136:139], v[112:115], v[32:35]
    ds_read_b128 v[180:183], v205 offset:7296
    v_mfma_f32_16x16x32_bf16 v[36:39], v[136:139], v[116:119], v[36:39]
    ds_read_b128 v[184:187], v205 offset:7360
    v_mfma_f32_16x16x32_bf16 v[52:55], v[140:143], v[116:119], v[52:55]
    ds_read_b128 v[188:191], v205 offset:7424
    v_mfma_f32_16x16x32_bf16 v[48:51], v[140:143], v[112:115], v[48:51]
    ds_read_b128 v[192:195], v205 offset:7488
    v_mfma_f32_16x16x32_bf16 v[64:67], v[144:147], v[112:115], v[64:67]
    ds_read_b128 v[196:199], v205 offset:7552
    v_mfma_f32_16x16x32_bf16 v[68:71], v[144:147], v[116:119], v[68:71]
    v_mfma_f32_16x16x32_bf16 v[84:87], v[148:151], v[116:119], v[84:87]
    v_mfma_f32_16x16x32_bf16 v[80:83], v[148:151], v[112:115], v[80:83]
    v_mfma_f32_16x16x32_bf16 v[96:99], v[152:155], v[112:115], v[96:99]
    v_mfma_f32_16x16x32_bf16 v[100:103], v[152:155], v[116:119], v[100:103]
    s_waitcnt lgkmcnt(0)
    v_mfma_f32_16x16x32_bf16 v[0:3], v[172:175], v[156:159], v[0:3]
    ds_read_b128 v[112:115], v203 offset:51200
    v_mfma_f32_16x16x32_bf16 v[16:19], v[176:179], v[156:159], v[16:19]
    ds_read_b128 v[128:131], v205 offset:47104
    v_mfma_f32_16x16x32_bf16 v[32:35], v[180:183], v[156:159], v[32:35]
    ds_read_b128 v[116:119], v203 offset:53248
    v_mfma_f32_16x16x32_bf16 v[48:51], v[184:187], v[156:159], v[48:51]
    ds_read_b128 v[132:135], v205 offset:47168
    v_mfma_f32_16x16x32_bf16 v[64:67], v[188:191], v[156:159], v[64:67]
    ds_read_b128 v[136:139], v205 offset:47232
    v_mfma_f32_16x16x32_bf16 v[80:83], v[192:195], v[156:159], v[80:83]
    ds_read_b128 v[140:143], v205 offset:47296
    v_mfma_f32_16x16x32_bf16 v[96:99], v[196:199], v[156:159], v[96:99]
    ds_read_b128 v[144:147], v205 offset:47360
    v_mfma_f32_16x16x32_bf16 v[4:7], v[172:175], v[160:163], v[4:7]
    ds_read_b128 v[148:151], v205 offset:47424
    v_mfma_f32_16x16x32_bf16 v[20:23], v[176:179], v[160:163], v[20:23]
    ds_read_b128 v[152:155], v205 offset:47488
    s_nop 5
    v_cvt_pk_bf16_f32 v224, v0, v1
    v_cvt_pk_bf16_f32 v225, v2, v3
    v_cvt_pk_bf16_f32 v226, v16, v17
    v_mfma_f32_16x16x32_bf16 v[36:39], v[180:183], v[160:163], v[36:39]
    v_cvt_pk_bf16_f32 v227, v18, v19
    ds_write_b128 v216, v[224:227] offset:0
    v_cvt_pk_bf16_f32 v228, v32, v33
    v_cvt_pk_bf16_f32 v229, v34, v35
    v_mfma_f32_16x16x32_bf16 v[52:55], v[184:187], v[160:163], v[52:55]
    v_cvt_pk_bf16_f32 v230, v48, v49
    v_cvt_pk_bf16_f32 v231, v50, v51
    ds_write_b128 v216, v[228:231] offset:64
    v_cvt_pk_bf16_f32 v232, v64, v65
    v_mfma_f32_16x16x32_bf16 v[68:71], v[188:191], v[160:163], v[68:71]
    v_cvt_pk_bf16_f32 v233, v66, v67
    v_cvt_pk_bf16_f32 v234, v80, v81
    v_cvt_pk_bf16_f32 v235, v82, v83
    ds_write_b128 v216, v[232:235] offset:128
    v_mfma_f32_16x16x32_bf16 v[84:87], v[192:195], v[160:163], v[84:87]
    v_cvt_pk_bf16_f32 v236, v96, v97
    v_cvt_pk_bf16_f32 v237, v98, v99
    ds_write_b64 v217, v[236:237] offset:192
    ds_read_b128 v[240:243], v218 offset:0
    v_mfma_f32_16x16x32_bf16 v[100:103], v[196:199], v[160:163], v[100:103]
    ds_read_b128 v[244:247], v218 offset:960
    ds_read_b128 v[248:251], v218 offset:1920
    ds_read_b128 v[252:255], v218 offset:2880
    s_waitcnt lgkmcnt(8)
    v_mfma_f32_16x16x32_bf16 v[8:11], v[128:131], v[112:115], v[8:11]
    ds_read_b128 v[156:159], v204 offset:51200
    v_mfma_f32_16x16x32_bf16 v[12:15], v[128:131], v[116:119], v[12:15]
    ds_read_b128 v[172:175], v205 offset:54272
    v_mfma_f32_16x16x32_bf16 v[28:31], v[132:135], v[116:119], v[28:31]
    ds_read_b128 v[160:163], v204 offset:53248
    v_mfma_f32_16x16x32_bf16 v[24:27], v[132:135], v[112:115], v[24:27]
    ds_read_b128 v[176:179], v205 offset:54336
    v_mfma_f32_16x16x32_bf16 v[40:43], v[136:139], v[112:115], v[40:43]
    ds_read_b128 v[180:183], v205 offset:54400
    v_mfma_f32_16x16x32_bf16 v[44:47], v[136:139], v[116:119], v[44:47]
    ds_read_b128 v[184:187], v205 offset:54464
    v_mfma_f32_16x16x32_bf16 v[60:63], v[140:143], v[116:119], v[60:63]
    ds_read_b128 v[188:191], v205 offset:54528
    v_mfma_f32_16x16x32_bf16 v[56:59], v[140:143], v[112:115], v[56:59]
    ds_read_b128 v[192:195], v205 offset:54592
    v_mfma_f32_16x16x32_bf16 v[72:75], v[144:147], v[112:115], v[72:75]
    ds_read_b128 v[196:199], v205 offset:54656
    s_waitcnt lgkmcnt(9)
    buffer_store_dwordx4 v[240:243], v219, s[32:35], s60 offen nt
    s_add_u32 s60, s60, 28672
    buffer_store_dwordx4 v[244:247], v219, s[32:35], s60 offen nt
    s_add_u32 s60, s60, 28672
    buffer_store_dwordx4 v[248:251], v219, s[32:35], s60 offen nt
    v_mfma_f32_16x16x32_bf16 v[76:79], v[144:147], v[116:119], v[76:79]
    s_add_u32 s60, s60, 28672
    buffer_store_dwordx4 v[252:255], v219, s[32:35], s60 offen nt
    s_add_u32 s60, s60, 28672
    v_cvt_pk_bf16_f32 v224, v4, v5
    v_cvt_pk_bf16_f32 v225, v6, v7
    v_cvt_pk_bf16_f32 v226, v20, v21
    v_mfma_f32_16x16x32_bf16 v[92:95], v[148:151], v[116:119], v[92:95]
    v_cvt_pk_bf16_f32 v227, v22, v23
    ds_write_b128 v216, v[224:227] offset:0
    v_cvt_pk_bf16_f32 v228, v36, v37
    v_cvt_pk_bf16_f32 v229, v38, v39
    v_cvt_pk_bf16_f32 v230, v52, v53
    v_cvt_pk_bf16_f32 v231, v54, v55
    v_mfma_f32_16x16x32_bf16 v[88:91], v[148:151], v[112:115], v[88:91]
    ds_write_b128 v216, v[228:231] offset:64
    v_cvt_pk_bf16_f32 v232, v68, v69
    v_cvt_pk_bf16_f32 v233, v70, v71
    v_cvt_pk_bf16_f32 v234, v84, v85
    v_cvt_pk_bf16_f32 v235, v86, v87
    ds_write_b128 v216, v[232:235] offset:128
    v_mfma_f32_16x16x32_bf16 v[104:107], v[152:155], v[112:115], v[104:107]
    v_cvt_pk_bf16_f32 v236, v100, v101
    v_cvt_pk_bf16_f32 v237, v102, v103
    ds_write_b64 v217, v[236:237] offset:192
    ds_read_b128 v[240:243], v218 offset:0
    ds_read_b128 v[244:247], v218 offset:960
    ds_read_b128 v[248:251], v218 offset:1920
    v_mfma_f32_16x16x32_bf16 v[108:111], v[152:155], v[116:119], v[108:111]
    ds_read_b128 v[252:255], v218 offset:2880
    s_waitcnt lgkmcnt(8)
    v_mfma_f32_16x16x32_bf16 v[8:11], v[172:175], v[156:159], v[8:11]
    ds_read_b128 v[112:115], v220 offset:4096
    v_mfma_f32_16x16x32_bf16 v[12:15], v[172:175], v[160:163], v[12:15]
    ds_read_b128 v[128:131], v222 offset:0
    v_mfma_f32_16x16x32_bf16 v[28:31], v[176:179], v[160:163], v[28:31]
    ds_read_b128 v[116:119], v220 offset:6144
    v_mfma_f32_16x16x32_bf16 v[24:27], v[176:179], v[156:159], v[24:27]
    ds_read_b128 v[132:135], v222 offset:64
    v_mfma_f32_16x16x32_bf16 v[40:43], v[180:183], v[156:159], v[40:43]
    ds_read_b128 v[136:139], v222 offset:128
    v_mfma_f32_16x16x32_bf16 v[44:47], v[180:183], v[160:163], v[44:47]
    ds_read_b128 v[140:143], v222 offset:192
    v_mfma_f32_16x16x32_bf16 v[60:63], v[184:187], v[160:163], v[60:63]
    ds_read_b128 v[144:147], v222 offset:256
    v_mfma_f32_16x16x32_bf16 v[56:59], v[184:187], v[156:159], v[56:59]
    ds_read_b128 v[148:151], v222 offset:320
    v_mfma_f32_16x16x32_bf16 v[72:75], v[188:191], v[156:159], v[72:75]
    ds_read_b128 v[152:155], v222 offset:384
    s_waitcnt lgkmcnt(9)
    buffer_store_dwordx4 v[240:243], v219, s[32:35], s60 offen nt
    v_mfma_f32_16x16x32_bf16 v[76:79], v[188:191], v[160:163], v[76:79]
    s_add_u32 s60, s60, 28672
    buffer_store_dwordx4 v[244:247], v219, s[32:35], s60 offen nt
    v_mfma_f32_16x16x32_bf16 v[92:95], v[192:195], v[160:163], v[92:95]
    s_add_u32 s60, s60, 28672
    buffer_store_dwordx4 v[248:251], v219, s[32:35], s60 offen nt
    v_mfma_f32_16x16x32_bf16 v[88:91], v[192:195], v[156:159], v[88:91]
    s_add_u32 s60, s60, 28672
    buffer_store_dwordx4 v[252:255], v219, s[32:35], s60 offen nt
    v_mfma_f32_16x16x32_bf16 v[104:107], v[196:199], v[156:159], v[104:107]
    s_add_u32 s60, s60, 28672
    v_mfma_f32_16x16x32_bf16 v[108:111], v[196:199], v[160:163], v[108:111]
    s_waitcnt lgkmcnt(0)
    v_mfma_f32_16x16x32_bf16 v[8:11], v[128:131], v[112:115], v[8:11]
    ds_read_b128 v[156:159], v221 offset:4096
    v_mfma_f32_16x16x32_bf16 v[12:15], v[128:131], v[116:119], v[12:15]
    ds_read_b128 v[172:175], v222 offset:7168
    v_mfma_f32_16x16x32_bf16 v[28:31], v[132:135], v[116:119], v[28:31]
    ds_read_b128 v[160:163], v221 offset:6144
    v_mfma_f32_16x16x32_bf16 v[24:27], v[132:135], v[112:115], v[24:27]
    ds_read_b128 v[176:179], v222 offset:7232
    v_mfma_f32_16x16x32_bf16 v[40:43], v[136:139], v[112:115], v[40:43]
    ds_read_b128 v[180:183], v222 offset:7296
    v_mfma_f32_16x16x32_bf16 v[44:47], v[136:139], v[116:119], v[44:47]
    ds_read_b128 v[184:187], v222 offset:7360
    v_mfma_f32_16x16x32_bf16 v[60:63], v[140:143], v[116:119], v[60:63]
    ds_read_b128 v[188:191], v222 offset:7424
    v_mfma_f32_16x16x32_bf16 v[56:59], v[140:143], v[112:115], v[56:59]
    ds_read_b128 v[192:195], v222 offset:7488
    v_mfma_f32_16x16x32_bf16 v[72:75], v[144:147], v[112:115], v[72:75]
    ds_read_b128 v[196:199], v222 offset:7552
    v_mfma_f32_16x16x32_bf16 v[76:79], v[144:147], v[116:119], v[76:79]
    v_mfma_f32_16x16x32_bf16 v[92:95], v[148:151], v[116:119], v[92:95]
    v_mfma_f32_16x16x32_bf16 v[88:91], v[148:151], v[112:115], v[88:91]
    v_mfma_f32_16x16x32_bf16 v[104:107], v[152:155], v[112:115], v[104:107]
    v_mfma_f32_16x16x32_bf16 v[108:111], v[152:155], v[116:119], v[108:111]
    s_waitcnt lgkmcnt(0)
    v_mfma_f32_16x16x32_bf16 v[8:11], v[172:175], v[156:159], v[8:11]
    ds_read_b128 v[112:115], v203 offset:4096
    v_mfma_f32_16x16x32_bf16 v[12:15], v[172:175], v[160:163], v[12:15]
    ds_read_b128 v[128:131], v205 offset:0
    v_mfma_f32_16x16x32_bf16 v[28:31], v[176:179], v[160:163], v[28:31]
    ds_read_b128 v[116:119], v203 offset:6144
    v_mfma_f32_16x16x32_bf16 v[24:27], v[176:179], v[156:159], v[24:27]
    ds_read_b128 v[132:135], v205 offset:64
    v_mfma_f32_16x16x32_bf16 v[40:43], v[180:183], v[156:159], v[40:43]
    ds_read_b128 v[136:139], v205 offset:128
    v_mfma_f32_16x16x32_bf16 v[44:47], v[180:183], v[160:163], v[44:47]
    ds_read_b128 v[140:143], v205 offset:192
    v_mfma_f32_16x16x32_bf16 v[60:63], v[184:187], v[160:163], v[60:63]
    ds_read_b128 v[144:147], v205 offset:256
    v_mfma_f32_16x16x32_bf16 v[56:59], v[184:187], v[156:159], v[56:59]
    ds_read_b128 v[148:151], v205 offset:320
    v_mfma_f32_16x16x32_bf16 v[72:75], v[188:191], v[156:159], v[72:75]
    ds_read_b128 v[152:155], v205 offset:384
    v_mfma_f32_16x16x32_bf16 v[76:79], v[188:191], v[160:163], v[76:79]
    v_mfma_f32_16x16x32_bf16 v[92:95], v[192:195], v[160:163], v[92:95]
    v_mfma_f32_16x16x32_bf16 v[88:91], v[192:195], v[156:159], v[88:91]
    v_mfma_f32_16x16x32_bf16 v[104:107], v[196:199], v[156:159], v[104:107]
    v_mfma_f32_16x16x32_bf16 v[108:111], v[196:199], v[160:163], v[108:111]
    s_waitcnt lgkmcnt(0)
    v_mfma_f32_16x16x32_bf16 v[8:11], v[128:131], v[112:115], v[8:11]
    ds_read_b128 v[156:159], v204 offset:4096
    v_mfma_f32_16x16x32_bf16 v[12:15], v[128:131], v[116:119], v[12:15]
    ds_read_b128 v[172:175], v205 offset:7168
    v_mfma_f32_16x16x32_bf16 v[28:31], v[132:135], v[116:119], v[28:31]
    ds_read_b128 v[160:163], v204 offset:6144
    v_mfma_f32_16x16x32_bf16 v[24:27], v[132:135], v[112:115], v[24:27]
    ds_read_b128 v[176:179], v205 offset:7232
    v_mfma_f32_16x16x32_bf16 v[40:43], v[136:139], v[112:115], v[40:43]
    ds_read_b128 v[180:183], v205 offset:7296
    v_mfma_f32_16x16x32_bf16 v[44:47], v[136:139], v[116:119], v[44:47]
    ds_read_b128 v[184:187], v205 offset:7360
    v_mfma_f32_16x16x32_bf16 v[60:63], v[140:143], v[116:119], v[60:63]
    ds_read_b128 v[188:191], v205 offset:7424
    v_mfma_f32_16x16x32_bf16 v[56:59], v[140:143], v[112:115], v[56:59]
    ds_read_b128 v[192:195], v205 offset:7488
    v_mfma_f32_16x16x32_bf16 v[72:75], v[144:147], v[112:115], v[72:75]
    ds_read_b128 v[196:199], v205 offset:7552
    v_mfma_f32_16x16x32_bf16 v[76:79], v[144:147], v[116:119], v[76:79]
    v_mfma_f32_16x16x32_bf16 v[92:95], v[148:151], v[116:119], v[92:95]
    v_mfma_f32_16x16x32_bf16 v[88:91], v[148:151], v[112:115], v[88:91]
    v_mfma_f32_16x16x32_bf16 v[104:107], v[152:155], v[112:115], v[104:107]
    v_mfma_f32_16x16x32_bf16 v[108:111], v[152:155], v[116:119], v[108:111]
    s_waitcnt lgkmcnt(0)
    v_mfma_f32_16x16x32_bf16 v[8:11], v[172:175], v[156:159], v[8:11]
    v_mfma_f32_16x16x32_bf16 v[24:27], v[176:179], v[156:159], v[24:27]
    v_mfma_f32_16x16x32_bf16 v[40:43], v[180:183], v[156:159], v[40:43]
    v_mfma_f32_16x16x32_bf16 v[56:59], v[184:187], v[156:159], v[56:59]
    v_mfma_f32_16x16x32_bf16 v[72:75], v[188:191], v[156:159], v[72:75]
    v_mfma_f32_16x16x32_bf16 v[88:91], v[192:195], v[156:159], v[88:91]
    v_mfma_f32_16x16x32_bf16 v[104:107], v[196:199], v[156:159], v[104:107]
    v_mfma_f32_16x16x32_bf16 v[12:15], v[172:175], v[160:163], v[12:15]
    v_mfma_f32_16x16x32_bf16 v[28:31], v[176:179], v[160:163], v[28:31]
    s_nop 5
    v_cvt_pk_bf16_f32 v224, v8, v9
    v_cvt_pk_bf16_f32 v225, v10, v11
    v_cvt_pk_bf16_f32 v226, v24, v25
    v_mfma_f32_16x16x32_bf16 v[44:47], v[180:183], v[160:163], v[44:47]
    v_cvt_pk_bf16_f32 v227, v26, v27
    ds_write_b128 v216, v[224:227] offset:0
    v_cvt_pk_bf16_f32 v228, v40, v41
    v_cvt_pk_bf16_f32 v229, v42, v43
    v_mfma_f32_16x16x32_bf16 v[60:63], v[184:187], v[160:163], v[60:63]
    v_cvt_pk_bf16_f32 v230, v56, v57
    v_cvt_pk_bf16_f32 v231, v58, v59
    ds_write_b128 v216, v[228:231] offset:64
    v_cvt_pk_bf16_f32 v232, v72, v73
    v_mfma_f32_16x16x32_bf16 v[76:79], v[188:191], v[160:163], v[76:79]
    v_cvt_pk_bf16_f32 v233, v74, v75
    v_cvt_pk_bf16_f32 v234, v88, v89
    v_cvt_pk_bf16_f32 v235, v90, v91
    ds_write_b128 v216, v[232:235] offset:128
    v_mfma_f32_16x16x32_bf16 v[92:95], v[192:195], v[160:163], v[92:95]
    v_cvt_pk_bf16_f32 v236, v104, v105
    v_cvt_pk_bf16_f32 v237, v106, v107
    ds_write_b64 v217, v[236:237] offset:192
    ds_read_b128 v[240:243], v218 offset:0
    v_mfma_f32_16x16x32_bf16 v[108:111], v[196:199], v[160:163], v[108:111]
    ds_read_b128 v[244:247], v218 offset:960
    ds_read_b128 v[248:251], v218 offset:1920
    ds_read_b128 v[252:255], v218 offset:2880
    s_waitcnt lgkmcnt(0)
    buffer_store_dwordx4 v[240:243], v219, s[32:35], s60 offen nt
    s_add_u32 s60, s60, 28672
    buffer_store_dwordx4 v[244:247], v219, s[32:35], s60 offen nt
    s_add_u32 s60, s60, 28672
    buffer_store_dwordx4 v[248:251], v219, s[32:35], s60 offen nt
    s_add_u32 s60, s60, 28672
    buffer_store_dwordx4 v[252:255], v219, s[32:35], s60 offen nt
    s_add_u32 s60, s60, 28672
    s_nop 1
    v_cvt_pk_bf16_f32 v224, v12, v13
    v_cvt_pk_bf16_f32 v225, v14, v15
    v_cvt_pk_bf16_f32 v226, v28, v29
    v_cvt_pk_bf16_f32 v227, v30, v31
    ds_write_b128 v216, v[224:227] offset:0
    v_cvt_pk_bf16_f32 v228, v44, v45
    v_cvt_pk_bf16_f32 v229, v46, v47
    v_cvt_pk_bf16_f32 v230, v60, v61
    v_cvt_pk_bf16_f32 v231, v62, v63
    ds_write_b128 v216, v[228:231] offset:64
    v_cvt_pk_bf16_f32 v232, v76, v77
    v_cvt_pk_bf16_f32 v233, v78, v79
    v_cvt_pk_bf16_f32 v234, v92, v93
    v_cvt_pk_bf16_f32 v235, v94, v95
    ds_write_b128 v216, v[232:235] offset:128
    v_cvt_pk_bf16_f32 v236, v108, v109
    v_cvt_pk_bf16_f32 v237, v110, v111
    ds_write_b64 v217, v[236:237] offset:192
    ds_read_b128 v[240:243], v218 offset:0
    ds_read_b128 v[244:247], v218 offset:960
    ds_read_b128 v[248:251], v218 offset:1920
    ds_read_b128 v[252:255], v218 offset:2880
    s_waitcnt lgkmcnt(0)
    buffer_store_dwordx4 v[240:243], v219, s[32:35], s60 offen nt
    s_add_u32 s60, s60, 28672
    buffer_store_dwordx4 v[244:247], v219, s[32:35], s60 offen nt
    s_add_u32 s60, s60, 28672
    buffer_store_dwordx4 v[248:251], v219, s[32:35], s60 offen nt
    s_add_u32 s60, s60, 28672
    buffer_store_dwordx4 v[252:255], v219, s[32:35], s60 offen nt
    s_add_u32 s60, s60, 28672
L_end:
    s_endpgm
L_loader:
    s_sub_u32 s73, s22, 4
    v_lshrrev_b32 v3, 3, v2
    s_lshl_b32 s56, s20, 8
    s_lshl_b32 s57, s73, 6
    s_add_u32 s56, s56, s57
    v_add_u32 v3, s56, v3
    v_lshlrev_b32 v3, 11, v3
    v_and_b32 v4, 7, v2
    v_lshrrev_b32 v5, 4, v2
    v_xor_b32 v4, v4, v5
    v_xor_b32 v5, 4, v4
    v_lshl_add_u32 v4, v4, 4, v3
    v_lshl_add_u32 v5, v5, 4, v3
    v_add_u32 v8, 0, v4
    v_add_u32 v9, 15360, v5
    v_add_u32 v10, 30720, v4
    v_add_u32 v11, 46080, v5
    v_add_u32 v12, 65536, v4
    v_add_u32 v13, 80896, v5
    v_add_u32 v14, 96256, v4
    v_add_u32 v15, 111616, v5
    s_lshl_b32 s61, s73, 13
    s_add_u32 s62, s61, 4096
    s_mul_i32 s72, s21, 229376
    s_lshl_b32 s64, s23, 7
    s_waitcnt lgkmcnt(0)
    s_mov_b32 s24, s4
    s_and_b32 s25, s5, 0xffff
    s_mov_b32 s26, 4194304
    s_mov_b32 s27, 0x00020000
    s_mov_b32 s66, 0
    s_add_u32 m0, s66, s61
    s_nop 0
    buffer_load_dwordx4 v8, s[24:27], s64 offen offset:0  lds
    buffer_load_dwordx4 v9, s[24:27], s64 offen offset:1024  lds
    buffer_load_dwordx4 v10, s[24:27], s64 offen offset:2048  lds
    buffer_load_dwordx4 v11, s[24:27], s64 offen offset:3072  lds
    s_add_u32 m0, s66, s62
    s_nop 0
    buffer_load_dwordx4 v12, s[24:27], s64 offen offset:0  lds
    buffer_load_dwordx4 v13, s[24:27], s64 offen offset:1024  lds
    buffer_load_dwordx4 v14, s[24:27], s64 offen offset:2048  lds
    buffer_load_dwordx4 v15, s[24:27], s64 offen offset:3072  lds
    s_mov_b32 s52, s16
    s_and_b32 s53, s17, 0xffff
    s_mov_b32 s54, 256
    s_mov_b32 s55, 0x00020000
    s_lshl_b32 s56, s73, 3
    s_or_b32 s56, s56, s2
    s_cmp_ge_u32 s56, 8
    s_cbranch_scc1 L_notag
    s_memrealtime s[58:59]
    s_waitcnt lgkmcnt(0)
    s_or_b32 s58, s58, 1
    v_mov_b32 v24, s58
    v_mov_b32 v25, 0
    s_mov_b64 exec, 1
    buffer_atomic_cmpswap v[24:25], off, s[52:55], 0
    s_mov_b64 exec, -1
L_notag:
    s_add_u32 s64, s64, 128
    s_mov_b32 s66, 47104
    s_add_u32 m0, s66, s61
    s_nop 0
    buffer_load_dwordx4 v8, s[24:27], s64 offen offset:0  lds
    buffer_load_dwordx4 v9, s[24:27], s64 offen offset:1024  lds
    buffer_load_dwordx4 v10, s[24:27], s64 offen offset:2048  lds
    buffer_load_dwordx4 v11, s[24:27], s64 offen offset:3072  lds
    s_add_u32 m0, s66, s62
    s_nop 0
    buffer_load_dwordx4 v12, s[24:27], s64 offen offset:0  lds
    buffer_load_dwordx4 v13, s[24:27], s64 offen offset:1024  lds
    buffer_load_dwordx4 v14, s[24:27], s64 offen offset:2048  lds
    buffer_load_dwordx4 v15, s[24:27], s64 offen offset:3072  lds
    s_cmp_ge_u32 s73, 2
    s_cbranch_scc1 L_notouch
    s_lshl_b32 s56, s73, 6
    v_add_u32 v26, s56, v2
    v_lshlrev_b32 v26, 7, v26
    s_lshl_b32 s56, s2, 14
    buffer_load_dword v26, v26, s[24:27], s56 offen
L_notouch:
    s_mov_b32 s28, s18
    s_and_b32 s29, s19, 0xffff
    s_mov_b32 s30, 8421376
    s_mov_b32 s31, 0x00020000
    s_lshl_b32 s57, s73, 12
    s_cmp_eq_u32 s73, 3
    s_cselect_b32 s57, 11264, s57
    s_add_u32 s63, s57, 32768
    v_lshlrev_b32 v16, 4, v2
    v_add_u32 v16, s57, v16
    v_add_u32 v23, 32768, v16
    s_lshl_b32 s56, s21, 10
    s_add_u32 s56, s56, 8388608
    s_lshl_b32 s57, s20, 7
    s_add_u32 s57, s57, s56
    s_lshl_b32 s58, s73, 2
    s_add_u32 s57, s57, s58
    v_mov_b32 v18, s57
    v_bfe_u32 v19, v2, 2, 3
    v_lshlrev_b32 v19, 7, v19
    v_and_b32 v3, 3, v2
    v_lshl_add_u32 v19, v3, 2, v19
    v_add_u32 v19, s56, v19
    v_mov_b32 v17, 141312
    v_mov_b32 v22, 0
    ds_write_b32 v17, v22
    s_add_u32 s75, s23, 1
    s_waitcnt vmcnt(8) lgkmcnt(0)
    s_barrier
    buffer_load_dword v21, off, s[52:55], 0 sc1
    s_cmp_ge_u32 s73, 2
    s_cbranch_scc1 L_loader3
    ds_read_b128 v[32:35], v23 offset:0
    ds_read_b128 v[36:39], v23 offset:1024
    ds_read_b128 v[40:43], v23 offset:2048
    ds_read_b128 v[44:47], v23 offset:3072
    s_mul_i32 s59, s23, 14336
    s_add_u32 s59, s59, s72
    s_waitcnt lgkmcnt(0)
    buffer_store_dwordx4 v[32:35], v16, s[28:31], s59 offen offset:0 sc1
    buffer_store_dwordx4 v[36:39], v16, s[28:31], s59 offen offset:1024 sc1
    buffer_store_dwordx4 v[40:43], v16, s[28:31], s59 offen offset:2048 sc1
    buffer_store_dwordx4 v[44:47], v16, s[28:31], s59 offen offset:3072 sc1
    s_barrier
    s_waitcnt vmcnt(0)
    s_mov_b32 s69, 0x40000
L_tagpolla:
    v_readfirstlane_b32 s58, v21
    s_sub_u32 s69, s69, 1
    s_cmp_eq_u32 s69, 0
    s_cbranch_scc1 L_tagdonea
    s_cmp_lg_u32 s58, 0
    s_cbranch_scc1 L_tagdonea
    buffer_load_dword v21, off, s[52:55], 0 sc1
    s_waitcnt vmcnt(0)
    s_branch L_tagpolla
L_tagdonea:
    s_mov_b64 exec, 1
    buffer_store_dword v21, v18, s[28:31], 0 offen offset:0 sc1
    s_mov_b64 exec, -1
    s_mov_b32 s70, 2
    s_cmp_ge_u32 s70, 9
    s_cselect_b32 s57, 8, 1
    s_cselect_b32 s58, 1, 0
    s_add_u32 s56, s20, s70
    s_sub_u32 s56, s56, s57
    s_and_b32 s56, s56, 7
    s_lshl_b32 s56, s56, 1
    s_add_u32 s56, s56, s58
    s_lshl_b32 s64, s56, 7
    s_mul_i32 s65, s56, 14336
    s_add_u32 s65, s65, s72
    s_add_u32 s70, s70, 1
    s_mov_b32 s66, 94208
    s_add_u32 m0, s66, s61
    s_nop 0
    buffer_load_dwordx4 v8, s[24:27], s64 offen offset:0  lds
    buffer_load_dwordx4 v9, s[24:27], s64 offen offset:1024  lds
    buffer_load_dwordx4 v10, s[24:27], s64 offen offset:2048  lds
    buffer_load_dwordx4 v11, s[24:27], s64 offen offset:3072  lds
    s_add_u32 m0, s66, s62
    s_nop 0
    buffer_load_dwordx4 v12, s[24:27], s64 offen offset:0  lds
    buffer_load_dwordx4 v13, s[24:27], s64 offen offset:1024  lds
    buffer_load_dwordx4 v14, s[24:27], s64 offen offset:2048  lds
    buffer_load_dwordx4 v15, s[24:27], s64 offen offset:3072  lds
    s_mov_b32 s69, 0x100000
    s_cmp_lg_u32 s73, 0
    s_cbranch_scc1 L_lpolla
L_gpoll:
    buffer_load_dword v22, v19, s[28:31], 0 offen sc1
    s_waitcnt vmcnt(0)
    v_cmp_eq_u32 vcc, v21, v22
    s_sub_u32 s69, s69, 1
    s_cmp_eq_u32 s69, 0
    s_cbranch_scc1 L_gdone
    s_cmp_eq_u64 vcc, -1
    s_cbranch_scc0 L_gpoll
L_gdone:
    v_mov_b32 v22, 1
    ds_write_b32 v17, v22
    s_branch L_polleda
L_lpolla:
    ds_read_b32 v22, v17
    s_waitcnt lgkmcnt(0)
    v_readfirstlane_b32 s56, v22
    s_nop 1
    s_cmp_eq_u32 s56, 0
    s_cbranch_scc1 L_lpolla
L_polleda:
    s_add_u32 m0, s66, s63
    s_nop 0
    buffer_load_dwordx4 v16, s[28:31], s65 offen offset:0 sc1 lds
    buffer_load_dwordx4 v16, s[28:31], s65 offen offset:1024 sc1 lds
    buffer_load_dwordx4 v16, s[28:31], s65 offen offset:2048 sc1 lds
    buffer_load_dwordx4 v16, s[28:31], s65 offen offset:3072 sc1 lds
    s_barrier
    s_cmp_ge_u32 s70, 9
    s_cselect_b32 s57, 8, 1
    s_cselect_b32 s58, 1, 0
    s_add_u32 s56, s20, s70
    s_sub_u32 s56, s56, s57
    s_and_b32 s56, s56, 7
    s_lshl_b32 s56, s56, 1
    s_add_u32 s56, s56, s58
    s_lshl_b32 s64, s56, 7
    s_mul_i32 s65, s56, 14336
    s_add_u32 s65, s65, s72
    s_add_u32 s70, s70, 1
    s_mov_b32 s66, 0
    s_add_u32 m0, s66, s61
    s_nop 0
    buffer_load_dwordx4 v8, s[24:27], s64 offen offset:0  lds
    buffer_load_dwordx4 v9, s[24:27], s64 offen offset:1024  lds
    buffer_load_dwordx4 v10, s[24:27], s64 offen offset:2048  lds
    buffer_load_dwordx4 v11, s[24:27], s64 offen offset:3072  lds
    s_add_u32 m0, s66, s62
    s_nop 0
    buffer_load_dwordx4 v12, s[24:27], s64 offen offset:0  lds
    buffer_load_dwordx4 v13, s[24:27], s64 offen offset:1024  lds
    buffer_load_dwordx4 v14, s[24:27], s64 offen offset:2048  lds
    buffer_load_dwordx4 v15, s[24:27], s64 offen offset:3072  lds
    s_add_u32 m0, s66, s63
    s_nop 0
    buffer_load_dwordx4 v16, s[28:31], s65 offen offset:0 sc1 lds
    buffer_load_dwordx4 v16, s[28:31], s65 offen offset:1024 sc1 lds
    buffer_load_dwordx4 v16, s[28:31], s65 offen offset:2048 sc1 lds
    buffer_load_dwordx4 v16, s[28:31], s65 offen offset:3072 sc1 lds
    ds_read_b128 v[32:35], v23 offset:47104
    ds_read_b128 v[36:39], v23 offset:48128
    ds_read_b128 v[40:43], v23 offset:49152
    ds_read_b128 v[44:47], v23 offset:50176
    s_mul_i32 s59, s75, 14336
    s_add_u32 s59, s59, s72
    s_waitcnt lgkmcnt(0)
    buffer_store_dwordx4 v[32:35], v16, s[28:31], s59 offen offset:0 sc1
    buffer_store_dwordx4 v[36:39], v16, s[28:31], s59 offen offset:1024 sc1
    buffer_store_dwordx4 v[40:43], v16, s[28:31], s59 offen offset:2048 sc1
    buffer_store_dwordx4 v[44:47], v16, s[28:31], s59 offen offset:3072 sc1
    s_waitcnt vmcnt(16)
    s_barrier
    s_cmp_ge_u32 s70, 9
    s_cselect_b32 s57, 8, 1
    s_cselect_b32 s58, 1, 0
    s_add_u32 s56, s20, s70
    s_sub_u32 s56, s56, s57
    s_and_b32 s56, s56, 7
    s_lshl_b32 s56, s56, 1
    s_add_u32 s56, s56, s58
    s_lshl_b32 s64, s56, 7
    s_mul_i32 s65, s56, 14336
    s_add_u32 s65, s65, s72
    s_add_u32 s70, s70, 1
    s_mov_b32 s66, 47104
    s_add_u32 m0, s66, s61
    s_nop 0
    buffer_load_dwordx4 v8, s[24:27], s64 offen offset:0  lds
    buffer_load_dwordx4 v9, s[24:27], s64 offen offset:1024  lds
    buffer_load_dwordx4 v10, s[24:27], s64 offen offset:2048  lds
    buffer_load_dwordx4 v11, s[24:27], s64 offen offset:3072  lds
    s_add_u32 m0, s66, s62
    s_nop 0
    buffer_load_dwordx4 v12, s[24:27], s64 offen offset:0  lds
    buffer_load_dwordx4 v13, s[24:27], s64 offen offset:1024  lds
    buffer_load_dwordx4 v14, s[24:27], s64 offen offset:2048  lds
    buffer_load_dwordx4 v15, s[24:27], s64 offen offset:3072  lds
    s_add_u32 m0, s66, s63
    s_nop 0
    buffer_load_dwordx4 v16, s[28:31], s65 offen offset:0 sc1 lds
    buffer_load_dwordx4 v16, s[28:31], s65 offen offset:1024 sc1 lds
    buffer_load_dwordx4 v16, s[28:31], s65 offen offset:2048 sc1 lds
    buffer_load_dwordx4 v16, s[28:31], s65 offen offset:3072 sc1 lds
    s_waitcnt vmcnt(12)
    s_mov_b64 exec, 1
    buffer_store_dword v21, v18, s[28:31], 0 offen offset:16 sc1
    s_mov_b64 exec, -1
    s_barrier
    s_cmp_ge_u32 s70, 9
    s_cselect_b32 s57, 8, 1
    s_cselect_b32 s58, 1, 0
    s_add_u32 s56, s20, s70
    s_sub_u32 s56, s56, s57
    s_and_b32 s56, s56, 7
    s_lshl_b32 s56, s56, 1
    s_add_u32 s56, s56, s58
    s_lshl_b32 s64, s56, 7
    s_mul_i32 s65, s56, 14336
    s_add_u32 s65, s65, s72
    s_add_u32 s70, s70, 1
    s_mov_b32 s66, 94208
    s_add_u32 m0, s66, s61
    s_nop 0
    buffer_load_dwordx4 v8, s[24:27], s64 offen offset:0  lds
    buffer_load_dwordx4 v9, s[24:27], s64 offen offset:1024  lds
    buffer_load_dwordx4 v10, s[24:27], s64 offen offset:2048  lds
    buffer_load_dwordx4 v11, s[24:27], s64 offen offset:3072  lds
    s_add_u32 m0, s66, s62
    s_nop 0
    buffer_load_dwordx4 v12, s[24:27], s64 offen offset:0  lds
    buffer_load_dwordx4 v13, s[24:27], s64 offen offset:1024  lds
    buffer_load_dwordx4 v14, s[24:27], s64 offen offset:2048  lds
    buffer_load_dwordx4 v15, s[24:27], s64 offen offset:3072  lds
    s_add_u32 m0, s66, s63
    s_nop 0
    buffer_load_dwordx4 v16, s[28:31], s65 offen offset:0 sc1 lds
    buffer_load_dwordx4 v16, s[28:31], s65 offen offset:1024 sc1 lds
    buffer_load_dwordx4 v16, s[28:31], s65 offen offset:2048 sc1 lds
    buffer_load_dwordx4 v16, s[28:31], s65 offen offset:3072 sc1 lds
    s_waitcnt vmcnt(13)
    s_barrier
    s_cmp_ge_u32 s70, 9
    s_cselect_b32 s57, 8, 1
    s_cselect_b32 s58, 1, 0
    s_add_u32 s56, s20, s70
    s_sub_u32 s56, s56, s57
    s_and_b32 s56, s56, 7
    s_lshl_b32 s56, s56, 1
    s_add_u32 s56, s56, s58
    s_lshl_b32 s64, s56, 7
    s_mul_i32 s65, s56, 14336
    s_add_u32 s65, s65, s72
    s_add_u32 s70, s70, 1
    s_mov_b32 s66, 0
    s_add_u32 m0, s66, s61
    s_nop 0
    buffer_load_dwordx4 v8, s[24:27], s64 offen offset:0  lds
    buffer_load_dwordx4 v9, s[24:27], s64 offen offset:1024  lds
    buffer_load_dwordx4 v10, s[24:27], s64 offen offset:2048  lds
    buffer_load_dwordx4 v11, s[24:27], s64 offen offset:3072  lds
    s_add_u32 m0, s66, s62
    s_nop 0
    buffer_load_dwordx4 v12, s[24:27], s64 offen offset:0  lds
    buffer_load_dwordx4 v13, s[24:27], s64 offen offset:1024  lds
    buffer_load_dwordx4 v14, s[24:27], s64 offen offset:2048  lds
    buffer_load_dwordx4 v15, s[24:27], s64 offen offset:3072  lds
    s_add_u32 m0, s66, s63
    s_nop 0
    buffer_load_dwordx4 v16, s[28:31], s65 offen offset:0 sc1 lds
    buffer_load_dwordx4 v16, s[28:31], s65 offen offset:1024 sc1 lds
    buffer_load_dwordx4 v16, s[28:31], s65 offen offset:2048 sc1 lds
    buffer_load_dwordx4 v16, s[28:31], s65 offen offset:3072 sc1 lds
    s_waitcnt vmcnt(12)
    s_barrier
    s_cmp_ge_u32 s70, 9
    s_cselect_b32 s57, 8, 1
    s_cselect_b32 s58, 1, 0
    s_add_u32 s56, s20, s70
    s_sub_u32 s56, s56, s57
    s_and_b32 s56, s56, 7
    s_lshl_b32 s56, s56, 1
    s_add_u32 s56, s56, s58
    s_lshl_b32 s64, s56, 7
    s_mul_i32 s65, s56, 14336
    s_add_u32 s65, s65, s72
    s_add_u32 s70, s70, 1
    s_mov_b32 s66, 47104
    s_add_u32 m0, s66, s61
    s_nop 0
    buffer_load_dwordx4 v8, s[24:27], s64 offen offset:0  lds
    buffer_load_dwordx4 v9, s[24:27], s64 offen offset:1024  lds
    buffer_load_dwordx4 v10, s[24:27], s64 offen offset:2048  lds
    buffer_load_dwordx4 v11, s[24:27], s64 offen offset:3072  lds
    s_add_u32 m0, s66, s62
    s_nop 0
    buffer_load_dwordx4 v12, s[24:27], s64 offen offset:0  lds
    buffer_load_dwordx4 v13, s[24:27], s64 offen offset:1024  lds
    buffer_load_dwordx4 v14, s[24:27], s64 offen offset:2048  lds
    buffer_load_dwordx4 v15, s[24:27], s64 offen offset:3072  lds
    s_add_u32 m0, s66, s63
    s_nop 0
    buffer_load_dwordx4 v16, s[28:31], s65 offen offset:0 sc1 lds
    buffer_load_dwordx4 v16, s[28:31], s65 offen offset:1024 sc1 lds
    buffer_load_dwordx4 v16, s[28:31], s65 offen offset:2048 sc1 lds
    buffer_load_dwordx4 v16, s[28:31], s65 offen offset:3072 sc1 lds
    s_waitcnt vmcnt(12)
    s_barrier
    buffer_load_dword v22, v19, s[28:31], 0 offen offset:16 sc1
    s_cmp_ge_u32 s70, 9
    s_cselect_b32 s57, 8, 1
    s_cselect_b32 s58, 1, 0
    s_add_u32 s56, s20, s70
    s_sub_u32 s56, s56, s57
    s_and_b32 s56, s56, 7
    s_lshl_b32 s56, s56, 1
    s_add_u32 s56, s56, s58
    s_lshl_b32 s64, s56, 7
    s_mul_i32 s65, s56, 14336
    s_add_u32 s65, s65, s72
    s_add_u32 s70, s70, 1
    s_mov_b32 s66, 94208
    s_add_u32 m0, s66, s61
    s_nop 0
    buffer_load_dwordx4 v8, s[24:27], s64 offen offset:0  lds
    buffer_load_dwordx4 v9, s[24:27], s64 offen offset:1024  lds
    buffer_load_dwordx4 v10, s[24:27], s64 offen offset:2048  lds
    buffer_load_dwordx4 v11, s[24:27], s64 offen offset:3072  lds
    s_add_u32 m0, s66, s62
    s_nop 0
    buffer_load_dwordx4 v12, s[24:27], s64 offen offset:0  lds
    buffer_load_dwordx4 v13, s[24:27], s64 offen offset:1024  lds
    buffer_load_dwordx4 v14, s[24:27], s64 offen offset:2048  lds
    buffer_load_dwordx4 v15, s[24:27], s64 offen offset:3072  lds
    s_add_u32 m0, s66, s63
    s_nop 0
    buffer_load_dwordx4 v16, s[28:31], s65 offen offset:0 sc1 lds
    buffer_load_dwordx4 v16, s[28:31], s65 offen offset:1024 sc1 lds
    buffer_load_dwordx4 v16, s[28:31], s65 offen offset:2048 sc1 lds
    buffer_load_dwordx4 v16, s[28:31], s65 offen offset:3072 sc1 lds
    s_waitcnt vmcnt(12)
    s_cmp_lg_u32 s73, 0
    s_cbranch_scc1 L_odd_ok
    s_mov_b32 s69, 0x100000
L_odd_chk:
    v_cmp_eq_u32 vcc, v21, v22
    s_sub_u32 s69, s69, 1
    s_cmp_eq_u32 s69, 0
    s_cbranch_scc1 L_odd_ok
    s_cmp_eq_u64 vcc, -1
    s_cbranch_scc1 L_odd_ok
    buffer_load_dword v22, v19, s[28:31], 0 offen offset:16 sc1
    s_waitcnt vmcnt(0)
    s_branch L_odd_chk
L_odd_ok:
    s_barrier
    s_mov_b32 s66, 0
L_ld_a:
    s_cmp_ge_u32 s70, 9
    s_cselect_b32 s57, 8, 1
    s_cselect_b32 s58, 1, 0
    s_add_u32 s56, s20, s70
    s_sub_u32 s56, s56, s57
    s_and_b32 s56, s56, 7
    s_lshl_b32 s56, s56, 1
    s_add_u32 s56, s56, s58
    s_lshl_b32 s64, s56, 7
    s_mul_i32 s65, s56, 14336
    s_add_u32 s65, s65, s72
    s_add_u32 s70, s70, 1
    s_add_u32 m0, s66, s61
    s_nop 0
    buffer_load_dwordx4 v8, s[24:27], s64 offen offset:0  lds
    buffer_load_dwordx4 v9, s[24:27], s64 offen offset:1024  lds
    buffer_load_dwordx4 v10, s[24:27], s64 offen offset:2048  lds
    buffer_load_dwordx4 v11, s[24:27], s64 offen offset:3072  lds
    s_add_u32 m0, s66, s62
    s_nop 0
    buffer_load_dwordx4 v12, s[24:27], s64 offen offset:0  lds
    buffer_load_dwordx4 v13, s[24:27], s64 offen offset:1024  lds
    buffer_load_dwordx4 v14, s[24:27], s64 offen offset:2048  lds
    buffer_load_dwordx4 v15, s[24:27], s64 offen offset:3072  lds
    s_add_u32 m0, s66, s63
    s_nop 0
    buffer_load_dwordx4 v16, s[28:31], s65 offen offset:0 sc1 lds
    buffer_load_dwordx4 v16, s[28:31], s65 offen offset:1024 sc1 lds
    buffer_load_dwordx4 v16, s[28:31], s65 offen offset:2048 sc1 lds
    buffer_load_dwordx4 v16, s[28:31], s65 offen offset:3072 sc1 lds
    s_add_u32 s66, s66, 47104
    s_cmp_eq_u32 s66, 141312
    s_cselect_b32 s66, 0, s66
    s_waitcnt vmcnt(12)
    s_cmp_lt_u32 s70, 16
    s_barrier
    s_cbranch_scc1 L_ld_a
    s_waitcnt vmcnt(0)
    s_barrier
    s_endpgm
L_loader3:
    ds_read_b128 v[32:35], v23 offset:0
    ds_read_b128 v[36:39], v23 offset:1024
    ds_read_b128 v[40:43], v23 offset:2048
    s_mul_i32 s59, s23, 14336
    s_add_u32 s59, s59, s72
    s_waitcnt lgkmcnt(0)
    buffer_store_dwordx4 v[32:35], v16, s[28:31], s59 offen offset:0 sc1
    buffer_store_dwordx4 v[36:39], v16, s[28:31], s59 offen offset:1024 sc1
    buffer_store_dwordx4 v[40:43], v16, s[28:31], s59 offen offset:2048 sc1
    s_barrier
    s_waitcnt vmcnt(0)
    s_mov_b32 s69, 0x40000
L_tagpollb:
    v_readfirstlane_b32 s58, v21
    s_sub_u32 s69, s69, 1
    s_cmp_eq_u32 s69, 0
    s_cbranch_scc1 L_tagdoneb
    s_cmp_lg_u32 s58, 0
    s_cbranch_scc1 L_tagdoneb
    buffer_load_dword v21, off, s[52:55], 0 sc1
    s_waitcnt vmcnt(0)
    s_branch L_tagpollb
L_tagdoneb:
    s_mov_b64 exec, 1
    buffer_store_dword v21, v18, s[28:31], 0 offen offset:0 sc1
    s_mov_b64 exec, -1
    s_mov_b32 s70, 2
    s_cmp_ge_u32 s70, 9
    s_cselect_b32 s57, 8, 1
    s_cselect_b32 s58, 1, 0
    s_add_u32 s56, s20, s70
    s_sub_u32 s56, s56, s57
    s_and_b32 s56, s56, 7
    s_lshl_b32 s56, s56, 1
    s_add_u32 s56, s56, s58
    s_lshl_b32 s64, s56, 7
    s_mul_i32 s65, s56, 14336
    s_add_u32 s65, s65, s72
    s_add_u32 s70, s70, 1
    s_mov_b32 s66, 94208
    s_add_u32 m0, s66, s61
    s_nop 0
    buffer_load_dwordx4 v8, s[24:27], s64 offen offset:0  lds
    buffer_load_dwordx4 v9, s[24:27], s64 offen offset:1024  lds
    buffer_load_dwordx4 v10, s[24:27], s64 offen offset:2048  lds
    buffer_load_dwordx4 v11, s[24:27], s64 offen offset:3072  lds
    s_add_u32 m0, s66, s62
    s_nop 0
    buffer_load_dwordx4 v12, s[24:27], s64 offen offset:0  lds
    buffer_load_dwordx4 v13, s[24:27], s64 offen offset:1024  lds
    buffer_load_dwordx4 v14, s[24:27], s64 offen offset:2048  lds
    buffer_load_dwordx4 v15, s[24:27], s64 offen offset:3072  lds
    s_mov_b32 s69, 0x100000
L_lpollb:
    ds_read_b32 v22, v17
    s_waitcnt lgkmcnt(0)
    v_readfirstlane_b32 s56, v22
    s_nop 1
    s_cmp_eq_u32 s56, 0
    s_cbranch_scc1 L_lpollb
L_polledb:
    s_add_u32 m0, s66, s63
    s_nop 0
    buffer_load_dwordx4 v16, s[28:31], s65 offen offset:0 sc1 lds
    buffer_load_dwordx4 v16, s[28:31], s65 offen offset:1024 sc1 lds
    buffer_load_dwordx4 v16, s[28:31], s65 offen offset:2048 sc1 lds
    s_barrier
    s_cmp_ge_u32 s70, 9
    s_cselect_b32 s57, 8, 1
    s_cselect_b32 s58, 1, 0
    s_add_u32 s56, s20, s70
    s_sub_u32 s56, s56, s57
    s_and_b32 s56, s56, 7
    s_lshl_b32 s56, s56, 1
    s_add_u32 s56, s56, s58
    s_lshl_b32 s64, s56, 7
    s_mul_i32 s65, s56, 14336
    s_add_u32 s65, s65, s72
    s_add_u32 s70, s70, 1
    s_mov_b32 s66, 0
    s_add_u32 m0, s66, s61
    s_nop 0
    buffer_load_dwordx4 v8, s[24:27], s64 offen offset:0  lds
    buffer_load_dwordx4 v9, s[24:27], s64 offen offset:1024  lds
    buffer_load_dwordx4 v10, s[24:27], s64 offen offset:2048  lds
    buffer_load_dwordx4 v11, s[24:27], s64 offen offset:3072  lds
    s_add_u32 m0, s66, s62
    s_nop 0
    buffer_load_dwordx4 v12, s[24:27], s64 offen offset:0  lds
    buffer_load_dwordx4 v13, s[24:27], s64 offen offset:1024  lds
    buffer_load_dwordx4 v14, s[24:27], s64 offen offset:2048  lds
    buffer_load_dwordx4 v15, s[24:27], s64 offen offset:3072  lds
    s_add_u32 m0, s66, s63
    s_nop 0
    buffer_load_dwordx4 v16, s[28:31], s65 offen offset:0 sc1 lds
    buffer_load_dwordx4 v16, s[28:31], s65 offen offset:1024 sc1 lds
    buffer_load_dwordx4 v16, s[28:31], s65 offen offset:2048 sc1 lds
    ds_read_b128 v[32:35], v23 offset:47104
    ds_read_b128 v[36:39], v23 offset:48128
    ds_read_b128 v[40:43], v23 offset:49152
    s_mul_i32 s59, s75, 14336
    s_add_u32 s59, s59, s72
    s_waitcnt lgkmcnt(0)
    buffer_store_dwordx4 v[32:35], v16, s[28:31], s59 offen offset:0 sc1
    buffer_store_dwordx4 v[36:39], v16, s[28:31], s59 offen offset:1024 sc1
    buffer_store_dwordx4 v[40:43], v16, s[28:31], s59 offen offset:2048 sc1
    s_waitcnt vmcnt(14)
    s_barrier
    s_cmp_ge_u32 s70, 9
    s_cselect_b32 s57, 8, 1
    s_cselect_b32 s58, 1, 0
    s_add_u32 s56, s20, s70
    s_sub_u32 s56, s56, s57
    s_and_b32 s56, s56, 7
    s_lshl_b32 s56, s56, 1
    s_add_u32 s56, s56, s58
    s_lshl_b32 s64, s56, 7
    s_mul_i32 s65, s56, 14336
    s_add_u32 s65, s65, s72
    s_add_u32 s70, s70, 1
    s_mov_b32 s66, 47104
    s_add_u32 m0, s66, s61
    s_nop 0
    buffer_load_dwordx4 v8, s[24:27], s64 offen offset:0  lds
    buffer_load_dwordx4 v9, s[24:27], s64 offen offset:1024  lds
    buffer_load_dwordx4 v10, s[24:27], s64 offen offset:2048  lds
    buffer_load_dwordx4 v11, s[24:27], s64 offen offset:3072  lds
    s_add_u32 m0, s66, s62
    s_nop 0
    buffer_load_dwordx4 v12, s[24:27], s64 offen offset:0  lds
    buffer_load_dwordx4 v13, s[24:27], s64 offen offset:1024  lds
    buffer_load_dwordx4 v14, s[24:27], s64 offen offset:2048  lds
    buffer_load_dwordx4 v15, s[24:27], s64 offen offset:3072  lds
    s_add_u32 m0, s66, s63
    s_nop 0
    buffer_load_dwordx4 v16, s[28:31], s65 offen offset:0 sc1 lds
    buffer_load_dwordx4 v16, s[28:31], s65 offen offset:1024 sc1 lds
    buffer_load_dwordx4 v16, s[28:31], s65 offen offset:2048 sc1 lds
    s_waitcnt vmcnt(11)
    s_mov_b64 exec, 1
    buffer_store_dword v21, v18, s[28:31], 0 offen offset:16 sc1
    s_mov_b64 exec, -1
    s_barrier
    s_cmp_ge_u32 s70, 9
    s_cselect_b32 s57, 8, 1
    s_cselect_b32 s58, 1, 0
    s_add_u32 s56, s20, s70
    s_sub_u32 s56, s56, s57
    s_and_b32 s56, s56, 7
    s_lshl_b32 s56, s56, 1
    s_add_u32 s56, s56, s58
    s_lshl_b32 s64, s56, 7
    s_mul_i32 s65, s56, 14336
    s_add_u32 s65, s65, s72
    s_add_u32 s70, s70, 1
    s_mov_b32 s66, 94208
    s_add_u32 m0, s66, s61
    s_nop 0
    buffer_load_dwordx4 v8, s[24:27], s64 offen offset:0  lds
    buffer_load_dwordx4 v9, s[24:27], s64 offen offset:1024  lds
    buffer_load_dwordx4 v10, s[24:27], s64 offen offset:2048  lds
    buffer_load_dwordx4 v11, s[24:27], s64 offen offset:3072  lds
    s_add_u32 m0, s66, s62
    s_nop 0
    buffer_load_dwordx4 v12, s[24:27], s64 offen offset:0  lds
    buffer_load_dwordx4 v13, s[24:27], s64 offen offset:1024  lds
    buffer_load_dwordx4 v14, s[24:27], s64 offen offset:2048  lds
    buffer_load_dwordx4 v15, s[24:27], s64 offen offset:3072  lds
    s_add_u32 m0, s66, s63
    s_nop 0
    buffer_load_dwordx4 v16, s[28:31], s65 offen offset:0 sc1 lds
    buffer_load_dwordx4 v16, s[28:31], s65 offen offset:1024 sc1 lds
    buffer_load_dwordx4 v16, s[28:31], s65 offen offset:2048 sc1 lds
    s_waitcnt vmcnt(12)
    s_barrier
    s_cmp_ge_u32 s70, 9
    s_cselect_b32 s57, 8, 1
    s_cselect_b32 s58, 1, 0
    s_add_u32 s56, s20, s70
    s_sub_u32 s56, s56, s57
    s_and_b32 s56, s56, 7
    s_lshl_b32 s56, s56, 1
    s_add_u32 s56, s56, s58
    s_lshl_b32 s64, s56, 7
    s_mul_i32 s65, s56, 14336
    s_add_u32 s65, s65, s72
    s_add_u32 s70, s70, 1
    s_mov_b32 s66, 0
    s_add_u32 m0, s66, s61
    s_nop 0
    buffer_load_dwordx4 v8, s[24:27], s64 offen offset:0  lds
    buffer_load_dwordx4 v9, s[24:27], s64 offen offset:1024  lds
    buffer_load_dwordx4 v10, s[24:27], s64 offen offset:2048  lds
    buffer_load_dwordx4 v11, s[24:27], s64 offen offset:3072  lds
    s_add_u32 m0, s66, s62
    s_nop 0
    buffer_load_dwordx4 v12, s[24:27], s64 offen offset:0  lds
    buffer_load_dwordx4 v13, s[24:27], s64 offen offset:1024  lds
    buffer_load_dwordx4 v14, s[24:27], s64 offen offset:2048  lds
    buffer_load_dwordx4 v15, s[24:27], s64 offen offset:3072  lds
    s_add_u32 m0, s66, s63
    s_nop 0
    buffer_load_dwordx4 v16, s[28:31], s65 offen offset:0 sc1 lds
    buffer_load_dwordx4 v16, s[28:31], s65 offen offset:1024 sc1 lds
    buffer_load_dwordx4 v16, s[28:31], s65 offen offset:2048 sc1 lds
    s_waitcnt vmcnt(11)
    s_barrier
    s_cmp_ge_u32 s70, 9
    s_cselect_b32 s57, 8, 1
    s_cselect_b32 s58, 1, 0
    s_add_u32 s56, s20, s70
    s_sub_u32 s56, s56, s57
    s_and_b32 s56, s56, 7
    s_lshl_b32 s56, s56, 1
    s_add_u32 s56, s56, s58
    s_lshl_b32 s64, s56, 7
    s_mul_i32 s65, s56, 14336
    s_add_u32 s65, s65, s72
    s_add_u32 s70, s70, 1
    s_mov_b32 s66, 47104
    s_add_u32 m0, s66, s61
    s_nop 0
    buffer_load_dwordx4 v8, s[24:27], s64 offen offset:0  lds
    buffer_load_dwordx4 v9, s[24:27], s64 offen offset:1024  lds
    buffer_load_dwordx4 v10, s[24:27], s64 offen offset:2048  lds
    buffer_load_dwordx4 v11, s[24:27], s64 offen offset:3072  lds
    s_add_u32 m0, s66, s62
    s_nop 0
    buffer_load_dwordx4 v12, s[24:27], s64 offen offset:0  lds
    buffer_load_dwordx4 v13, s[24:27], s64 offen offset:1024  lds
    buffer_load_dwordx4 v14, s[24:27], s64 offen offset:2048  lds
    buffer_load_dwordx4 v15, s[24:27], s64 offen offset:3072  lds
    s_add_u32 m0, s66, s63
    s_nop 0
    buffer_load_dwordx4 v16, s[28:31], s65 offen offset:0 sc1 lds
    buffer_load_dwordx4 v16, s[28:31], s65 offen offset:1024 sc1 lds
    buffer_load_dwordx4 v16, s[28:31], s65 offen offset:2048 sc1 lds
    s_waitcnt vmcnt(11)
    s_barrier
    s_cmp_ge_u32 s70, 9
    s_cselect_b32 s57, 8, 1
    s_cselect_b32 s58, 1, 0
    s_add_u32 s56, s20, s70
    s_sub_u32 s56, s56, s57
    s_and_b32 s56, s56, 7
    s_lshl_b32 s56, s56, 1
    s_add_u32 s56, s56, s58
    s_lshl_b32 s64, s56, 7
    s_mul_i32 s65, s56, 14336
    s_add_u32 s65, s65, s72
    s_add_u32 s70, s70, 1
    s_mov_b32 s66, 94208
    s_add_u32 m0, s66, s61
    s_nop 0
    buffer_load_dwordx4 v8, s[24:27], s64 offen offset:0  lds
    buffer_load_dwordx4 v9, s[24:27], s64 offen offset:1024  lds
    buffer_load_dwordx4 v10, s[24:27], s64 offen offset:2048  lds
    buffer_load_dwordx4 v11, s[24:27], s64 offen offset:3072  lds
    s_add_u32 m0, s66, s62
    s_nop 0
    buffer_load_dwordx4 v12, s[24:27], s64 offen offset:0  lds
    buffer_load_dwordx4 v13, s[24:27], s64 offen offset:1024  lds
    buffer_load_dwordx4 v14, s[24:27], s64 offen offset:2048  lds
    buffer_load_dwordx4 v15, s[24:27], s64 offen offset:3072  lds
    s_add_u32 m0, s66, s63
    s_nop 0
    buffer_load_dwordx4 v16, s[28:31], s65 offen offset:0 sc1 lds
    buffer_load_dwordx4 v16, s[28:31], s65 offen offset:1024 sc1 lds
    buffer_load_dwordx4 v16, s[28:31], s65 offen offset:2048 sc1 lds
    s_waitcnt vmcnt(11)
    s_barrier
    s_mov_b32 s66, 0
L_ld_b:
    s_cmp_ge_u32 s70, 9
    s_cselect_b32 s57, 8, 1
    s_cselect_b32 s58, 1, 0
    s_add_u32 s56, s20, s70
    s_sub_u32 s56, s56, s57
    s_and_b32 s56, s56, 7
    s_lshl_b32 s56, s56, 1
    s_add_u32 s56, s56, s58
    s_lshl_b32 s64, s56, 7
    s_mul_i32 s65, s56, 14336
    s_add_u32 s65, s65, s72
    s_add_u32 s70, s70, 1
    s_add_u32 m0, s66, s61
    s_nop 0
    buffer_load_dwordx4 v8, s[24:27], s64 offen offset:0  lds
    buffer_load_dwordx4 v9, s[24:27], s64 offen offset:1024  lds
    buffer_load_dwordx4 v10, s[24:27], s64 offen offset:2048  lds
    buffer_load_dwordx4 v11, s[24:27], s64 offen offset:3072  lds
    s_add_u32 m0, s66, s62
    s_nop 0
    buffer_load_dwordx4 v12, s[24:27], s64 offen offset:0  lds
    buffer_load_dwordx4 v13, s[24:27], s64 offen offset:1024  lds
    buffer_load_dwordx4 v14, s[24:27], s64 offen offset:2048  lds
    buffer_load_dwordx4 v15, s[24:27], s64 offen offset:3072  lds
    s_add_u32 m0, s66, s63
    s_nop 0
    buffer_load_dwordx4 v16, s[28:31], s65 offen offset:0 sc1 lds
    buffer_load_dwordx4 v16, s[28:31], s65 offen offset:1024 sc1 lds
    buffer_load_dwordx4 v16, s[28:31], s65 offen offset:2048 sc1 lds
    s_add_u32 s66, s66, 47104
    s_cmp_eq_u32 s66, 141312
    s_cselect_b32 s66, 0, s66
    s_waitcnt vmcnt(11)
    s_cmp_lt_u32 s70, 16
    s_barrier
    s_cbranch_scc1 L_ld_b
    s_waitcnt vmcnt(0)
    s_barrier
    s_endpgm
.section .rodata,"a"
.p2align 6
.amdhsa_kernel standalone__weight_only_int_omniquant__prompt_kernel
  .amdhsa_next_free_vgpr 256
  .amdhsa_next_free_sgpr 102
  .amdhsa_accum_offset 256
  .amdhsa_group_segment_fixed_size 0
  .amdhsa_kernarg_size 64
  .amdhsa_user_sgpr_count 2
  .amdhsa_user_sgpr_kernarg_segment_ptr 1
  .amdhsa_system_sgpr_workgroup_id_x 1
.end_amdhsa_kernel
.text
```
